```python
import torch

def _softmax(x, axis=-1):
    return torch.softmax(x, dim=axis)
def _gelu(x):
    return torch.nn.functional.gelu(x, approximate="tanh")
def _silu(x):
    return torch.nn.functional.silu(x)
def _sigmoid(x):
    return torch.sigmoid(x)
def _layernorm(x, axis=-1, eps=1e-5):
    m = x.mean(dim=axis, keepdim=True)
    v = x.var(dim=axis, keepdim=True, unbiased=False)
    return (x - m) / torch.sqrt(v + eps)
def _scatter_add(tgt, idx, src, axis=0):
    return tgt.clone().index_add_(axis, idx, src)
def _segment_sum(src, seg, n):
    out = torch.zeros((n,) + src.shape[1:], dtype=src.dtype)
    return out.index_add_(0, seg, src)
def _pad(x, pw):
    flat = tuple(v for pair in reversed(pw) for v in pair)
    return torch.nn.functional.pad(x, flat)

kernel_name = 'gated_mix__mha_block__mixer_token_mlp__prompt'

def setup_inputs():

    _w = (lambda a: (lambda t: t.to(torch.bfloat16) if t.is_floating_point() else t)(torch.as_tensor(a)))
    def _A_setup():
        B, S, D, H = 1, 2048, 512, 32
        return {
            "x": _w((lambda *s: torch.randn(*s, dtype=torch.bfloat16) * 0.05)(B, S, D)),
            "wqkv": _w((lambda *s: torch.randn(*s, dtype=torch.bfloat16) * 0.8)(D, 3 * D)),
            "wo": _w((lambda *s: torch.randn(*s, dtype=torch.bfloat16) * 0.05)(D, D)),
        }
    _A_in = _A_setup()

    def _B_setup():
        B, S, D, F = 1, 2048, 512, 1792
        return {
            "x": _w((lambda *s: torch.randn(*s, dtype=torch.bfloat16) * 0.05)(B, S, D)),
            "w1": _w((lambda *s: torch.randn(*s, dtype=torch.bfloat16) * 0.8)(S, F) * (S ** -0.5)),
            "b1": _w((lambda *s: torch.randn(*s, dtype=torch.bfloat16) * 12.8)(F) * 0.02),
            "w2": _w((lambda *s: torch.randn(*s, dtype=torch.bfloat16) * 0.05)(F, S) * (F ** -0.5)),
            "b2": _w((lambda *s: torch.randn(*s, dtype=torch.bfloat16) * 0.8)(S) * 0.02),
        }
    _B_in = _B_setup()

    return {
        "A_x": _A_in["x"],
        "A_wqkv": _A_in["wqkv"],
        "A_wo": _A_in["wo"],
        "B_x": _B_in["x"],
        "B_w1": _B_in["w1"],
        "B_b1": _B_in["b1"],
        "B_w2": _B_in["w2"],
        "B_b2": _B_in["b2"],
        "gate_w": _w((lambda *s: torch.randn(*s, dtype=torch.bfloat16) * 0.05)(512) * 16.0),
    }

def reference(A_x, A_wqkv, A_wo, B_x, B_w1, B_b1, B_w2, B_b2, gate_w):
    def _A_ref(x, wqkv, wo):
        B, S, D = x.shape
        H = 32
        Dh = D // H
        qkv = (lambda x, *d: x.permute(*d))((x @ wqkv).reshape(B, S, 3, H, Dh), 2, 0, 3, 1, 4)
        q, k, v = qkv[0], qkv[1], qkv[2]
        scores = torch.einsum("bhqd,bhkd->bhqk", q, k) * (Dh ** -0.5)
        p = _softmax(scores, axis=-1)
        o = torch.einsum("bhqk,bhkd->bhqd", p, v)
        return (lambda x, *d: x.permute(*d))(o, 0, 2, 1, 3).reshape(B, S, D) @ wo

    def _B_ref(x, w1, b1, w2, b2):
        B, S, D = x.shape
        h = _layernorm(x, axis=-1)
        u = torch.einsum("bsd,sf->bdf", h, w1) + b1
        u = _gelu(u)
        y = torch.einsum("bdf,fs->bds", u, w2) + b2
        return (lambda x, *d: x.permute(*d))(y, 0, 2, 1)

    x = A_x
    g = _sigmoid((x * gate_w).sum(-1, keepdims=True))
    a = _A_ref(x, A_wqkv, A_wo)
    b = _B_ref(x, B_w1, B_b1, B_w2, B_b2)
    return g * a + (1 - g) * b
```

```asm
; @launch grid=(512,1,1) block=(512,1,1) lds=81920
.amdgcn_target "amdgcn-amd-amdhsa--gfx950"
.text
.globl gated_mix__mha_block__mixer_token_mlp__prompt_kernel
.p2align 8
.type gated_mix__mha_block__mixer_token_mlp__prompt_kernel,@function
gated_mix__mha_block__mixer_token_mlp__prompt_kernel:
K_START:
  s_cmp_ge_u32 s2, 512
  s_cbranch_scc1 K_END
  s_load_dwordx16 s[4:19], s[0:1], 0
  s_load_dwordx8 s[20:27], s[0:1], 64
  v_and_b32 v1, 63, v0
  v_lshrrev_b32 v2, 6, v0
  s_nop 0
  v_readfirstlane_b32 s30, v2
  s_cmp_ge_u32 s2, 256
  s_cbranch_scc1 ROLE_B
  s_and_b32 s48, s2, 7
  s_lshr_b32 s49, s2, 3
  s_and_b32 s50, s48, 3
  s_lshl_b32 s50, s50, 3
  s_and_b32 s51, s49, 7
  s_add_u32 s52, s50, s51
  s_lshr_b32 s50, s48, 2
  s_lshl_b32 s50, s50, 2
  s_lshr_b32 s51, s49, 3
  s_add_u32 s53, s50, s51
  s_mov_b32 s52, s49
  s_mov_b32 s53, s48
  s_cmp_lt_u32 s30, 4
  s_cbranch_scc1 QKV_COMPUTE
  s_sub_u32 s54, s30, 4
  v_lshrrev_b32 v2, 3, v1
  v_lshrrev_b32 v3, 4, v1
  v_and_b32 v4, 7, v1
  s_lshl_b32 s55, s52, 6
  s_lshl_b32 s56, s54, 4
  s_add_u32 s55, s55, s56
  v_add_u32 v7, s55, v2
  v_lshlrev_b32 v7, 10, v7
  v_add_u32 v8, 8192, v7
  v_xor_b32 v10, v4, v3
  v_xor_b32 v11, 4, v10
  v_lshl_add_u32 v7, v10, 4, v7
  v_lshl_add_u32 v8, v11, 4, v8
  s_lshl_b32 s56, s54, 3
  v_add_u32 v9, s56, v2
  v_mul_u32_u24 v9, 3072, v9
  v_and_b32 v10, 1, v3
  v_lshlrev_b32 v10, 2, v10
  v_xor_b32 v10, v4, v10
  v_lshl_add_u32 v9, v10, 4, v9
  s_lshl_b32 s56, s53, 7
  v_add_u32 v9, s56, v9
  s_lshl_b32 s57, s54, 11
  s_mul_i32 s58, s54, 3072
  s_add_u32 s58, s58, 24576
  s_waitcnt lgkmcnt(0)
  s_mov_b32 s36, s4
  s_mov_b32 s37, s5
  s_mov_b32 s38, 2097152
  s_mov_b32 s39, 0x00020000
  s_mov_b32 s40, s6
  s_mov_b32 s41, s7
  s_mov_b32 s42, 1572864
  s_mov_b32 s43, 0x00020000
  s_mov_b32 s32, s26
  s_mov_b32 s33, s27
  s_mov_b32 s34, 16777216
  s_mov_b32 s35, 0x00020000
  s_add_u32 s64, s26, 12615680
  s_addc_u32 s65, s27, 0
  s_load_dwordx2 s[66:67], s[64:65], 0
  s_lshl_b32 s68, s53, 1
  s_add_u32 s68, s68, s52
  s_add_u32 s62, s68, 0
  s_and_b32 s62, s62, 7
  s_lshl_b32 s59, s62, 7
  s_add_u32 m0, s57, 0
  s_nop 0
  buffer_load_dwordx4 v7, s[36:39], s59 offen lds
  s_add_u32 m0, s57, 1024
  s_nop 0
  buffer_load_dwordx4 v8, s[36:39], s59 offen lds
  s_add_u32 s62, s68, 0
  s_and_b32 s62, s62, 7
  s_mul_i32 s60, s62, 196608
  s_add_u32 m0, s58, 0
  s_nop 0
  buffer_load_dwordx4 v9, s[40:43], s60 offen offset:0 lds
  buffer_load_dwordx4 v9, s[40:43], s60 offen offset:1024 lds
  buffer_load_dwordx4 v9, s[40:43], s60 offen offset:2048 lds
  s_add_u32 s60, s60, 98304
  s_add_u32 m0, s58, 12288
  s_nop 0
  buffer_load_dwordx4 v9, s[40:43], s60 offen offset:0 lds
  buffer_load_dwordx4 v9, s[40:43], s60 offen offset:1024 lds
  buffer_load_dwordx4 v9, s[40:43], s60 offen offset:2048 lds
  s_add_u32 s62, s68, 1
  s_and_b32 s62, s62, 7
  s_lshl_b32 s59, s62, 7
  s_add_u32 m0, s57, 8192
  s_nop 0
  buffer_load_dwordx4 v7, s[36:39], s59 offen lds
  s_add_u32 m0, s57, 9216
  s_nop 0
  buffer_load_dwordx4 v8, s[36:39], s59 offen lds
  s_add_u32 s62, s68, 1
  s_and_b32 s62, s62, 7
  s_mul_i32 s60, s62, 196608
  s_add_u32 m0, s58, 24576
  s_nop 0
  buffer_load_dwordx4 v9, s[40:43], s60 offen offset:0 lds
  buffer_load_dwordx4 v9, s[40:43], s60 offen offset:1024 lds
  buffer_load_dwordx4 v9, s[40:43], s60 offen offset:2048 lds
  s_add_u32 s60, s60, 98304
  s_add_u32 m0, s58, 36864
  s_nop 0
  buffer_load_dwordx4 v9, s[40:43], s60 offen offset:0 lds
  buffer_load_dwordx4 v9, s[40:43], s60 offen offset:1024 lds
  buffer_load_dwordx4 v9, s[40:43], s60 offen offset:2048 lds
  s_lshl_b32 s61, s2, 7
  s_add_u32 s61, s61, 12779520
  s_waitcnt vmcnt(11)
  s_barrier
  s_waitcnt vmcnt(8)
  s_barrier
  s_add_u32 s62, s68, 2
  s_and_b32 s62, s62, 7
  s_lshl_b32 s59, s62, 7
  s_add_u32 m0, s57, 16384
  s_nop 0
  buffer_load_dwordx4 v7, s[36:39], s59 offen lds
  s_add_u32 m0, s57, 17408
  s_nop 0
  buffer_load_dwordx4 v8, s[36:39], s59 offen lds
  s_add_u32 s62, s68, 2
  s_and_b32 s62, s62, 7
  s_mul_i32 s60, s62, 196608
  s_add_u32 m0, s58, 0
  s_nop 0
  buffer_load_dwordx4 v9, s[40:43], s60 offen offset:0 lds
  buffer_load_dwordx4 v9, s[40:43], s60 offen offset:1024 lds
  buffer_load_dwordx4 v9, s[40:43], s60 offen offset:2048 lds
  s_waitcnt vmcnt(8)
  s_barrier
  s_add_u32 s60, s60, 98304
  s_add_u32 m0, s58, 12288
  s_nop 0
  buffer_load_dwordx4 v9, s[40:43], s60 offen offset:0 lds
  buffer_load_dwordx4 v9, s[40:43], s60 offen offset:1024 lds
  buffer_load_dwordx4 v9, s[40:43], s60 offen offset:2048 lds
  s_waitcnt vmcnt(8)
  s_barrier
  s_add_u32 s62, s68, 3
  s_and_b32 s62, s62, 7
  s_lshl_b32 s59, s62, 7
  s_add_u32 m0, s57, 0
  s_nop 0
  buffer_load_dwordx4 v7, s[36:39], s59 offen lds
  s_add_u32 m0, s57, 1024
  s_nop 0
  buffer_load_dwordx4 v8, s[36:39], s59 offen lds
  s_add_u32 s62, s68, 3
  s_and_b32 s62, s62, 7
  s_mul_i32 s60, s62, 196608
  s_add_u32 m0, s58, 24576
  s_nop 0
  buffer_load_dwordx4 v9, s[40:43], s60 offen offset:0 lds
  buffer_load_dwordx4 v9, s[40:43], s60 offen offset:1024 lds
  buffer_load_dwordx4 v9, s[40:43], s60 offen offset:2048 lds
  s_waitcnt vmcnt(8)
  s_barrier
  s_add_u32 s60, s60, 98304
  s_add_u32 m0, s58, 36864
  s_nop 0
  buffer_load_dwordx4 v9, s[40:43], s60 offen offset:0 lds
  buffer_load_dwordx4 v9, s[40:43], s60 offen offset:1024 lds
  buffer_load_dwordx4 v9, s[40:43], s60 offen offset:2048 lds
  s_waitcnt vmcnt(8)
  s_barrier
  s_add_u32 s62, s68, 4
  s_and_b32 s62, s62, 7
  s_lshl_b32 s59, s62, 7
  s_add_u32 m0, s57, 8192
  s_nop 0
  buffer_load_dwordx4 v7, s[36:39], s59 offen lds
  s_add_u32 m0, s57, 9216
  s_nop 0
  buffer_load_dwordx4 v8, s[36:39], s59 offen lds
  s_add_u32 s62, s68, 4
  s_and_b32 s62, s62, 7
  s_mul_i32 s60, s62, 196608
  s_add_u32 m0, s58, 0
  s_nop 0
  buffer_load_dwordx4 v9, s[40:43], s60 offen offset:0 lds
  buffer_load_dwordx4 v9, s[40:43], s60 offen offset:1024 lds
  buffer_load_dwordx4 v9, s[40:43], s60 offen offset:2048 lds
  s_waitcnt vmcnt(8)
  s_barrier
  s_add_u32 s60, s60, 98304
  s_add_u32 m0, s58, 12288
  s_nop 0
  buffer_load_dwordx4 v9, s[40:43], s60 offen offset:0 lds
  buffer_load_dwordx4 v9, s[40:43], s60 offen offset:1024 lds
  buffer_load_dwordx4 v9, s[40:43], s60 offen offset:2048 lds
  s_waitcnt vmcnt(8)
  s_barrier
  s_add_u32 s62, s68, 5
  s_and_b32 s62, s62, 7
  s_lshl_b32 s59, s62, 7
  s_add_u32 m0, s57, 16384
  s_nop 0
  buffer_load_dwordx4 v7, s[36:39], s59 offen lds
  s_add_u32 m0, s57, 17408
  s_nop 0
  buffer_load_dwordx4 v8, s[36:39], s59 offen lds
  s_add_u32 s62, s68, 5
  s_and_b32 s62, s62, 7
  s_mul_i32 s60, s62, 196608
  s_add_u32 m0, s58, 24576
  s_nop 0
  buffer_load_dwordx4 v9, s[40:43], s60 offen offset:0 lds
  buffer_load_dwordx4 v9, s[40:43], s60 offen offset:1024 lds
  buffer_load_dwordx4 v9, s[40:43], s60 offen offset:2048 lds
  s_waitcnt vmcnt(8)
  s_barrier
  s_add_u32 s60, s60, 98304
  s_add_u32 m0, s58, 36864
  s_nop 0
  buffer_load_dwordx4 v9, s[40:43], s60 offen offset:0 lds
  buffer_load_dwordx4 v9, s[40:43], s60 offen offset:1024 lds
  buffer_load_dwordx4 v9, s[40:43], s60 offen offset:2048 lds
  s_waitcnt vmcnt(8)
  s_barrier
  s_add_u32 s62, s68, 6
  s_and_b32 s62, s62, 7
  s_lshl_b32 s59, s62, 7
  s_add_u32 m0, s57, 0
  s_nop 0
  buffer_load_dwordx4 v7, s[36:39], s59 offen lds
  s_add_u32 m0, s57, 1024
  s_nop 0
  buffer_load_dwordx4 v8, s[36:39], s59 offen lds
  s_add_u32 s62, s68, 6
  s_and_b32 s62, s62, 7
  s_mul_i32 s60, s62, 196608
  s_add_u32 m0, s58, 0
  s_nop 0
  buffer_load_dwordx4 v9, s[40:43], s60 offen offset:0 lds
  buffer_load_dwordx4 v9, s[40:43], s60 offen offset:1024 lds
  buffer_load_dwordx4 v9, s[40:43], s60 offen offset:2048 lds
  s_waitcnt vmcnt(8)
  s_barrier
  s_add_u32 s60, s60, 98304
  s_add_u32 m0, s58, 12288
  s_nop 0
  buffer_load_dwordx4 v9, s[40:43], s60 offen offset:0 lds
  buffer_load_dwordx4 v9, s[40:43], s60 offen offset:1024 lds
  buffer_load_dwordx4 v9, s[40:43], s60 offen offset:2048 lds
  s_waitcnt vmcnt(8)
  s_barrier
  s_add_u32 s62, s68, 7
  s_and_b32 s62, s62, 7
  s_lshl_b32 s59, s62, 7
  s_add_u32 m0, s57, 8192
  s_nop 0
  buffer_load_dwordx4 v7, s[36:39], s59 offen lds
  s_add_u32 m0, s57, 9216
  s_nop 0
  buffer_load_dwordx4 v8, s[36:39], s59 offen lds
  s_add_u32 s62, s68, 7
  s_and_b32 s62, s62, 7
  s_mul_i32 s60, s62, 196608
  s_add_u32 m0, s58, 24576
  s_nop 0
  buffer_load_dwordx4 v9, s[40:43], s60 offen offset:0 lds
  buffer_load_dwordx4 v9, s[40:43], s60 offen offset:1024 lds
  buffer_load_dwordx4 v9, s[40:43], s60 offen offset:2048 lds
  s_waitcnt vmcnt(8)
  s_barrier
  s_add_u32 s60, s60, 98304
  s_add_u32 m0, s58, 36864
  s_nop 0
  buffer_load_dwordx4 v9, s[40:43], s60 offen offset:0 lds
  buffer_load_dwordx4 v9, s[40:43], s60 offen offset:1024 lds
  buffer_load_dwordx4 v9, s[40:43], s60 offen offset:2048 lds
  s_waitcnt vmcnt(8)
  s_barrier
  s_waitcnt vmcnt(3)
  s_barrier
  s_waitcnt vmcnt(0)
  s_barrier
  s_barrier
  s_branch QKV_DONE
QKV_COMPUTE:
  s_and_b32 s54, s30, 1
  s_lshr_b32 s55, s30, 1
  v_and_b32 v10, 31, v1
  s_lshl_b32 s56, s54, 5
  v_add_u32 v10, s56, v10
  v_lshrrev_b32 v11, 1, v10
  v_and_b32 v11, 7, v11
  v_lshrrev_b32 v12, 5, v1
  v_xor_b32 v11, v11, v12
  v_lshlrev_b32 v10, 7, v10
  v_xor_b32 v13, 0, v11
  v_lshl_add_u32 v2, v13, 4, v10
  v_xor_b32 v13, 2, v11
  v_lshl_add_u32 v3, v13, 4, v10
  v_xor_b32 v13, 4, v11
  v_lshl_add_u32 v4, v13, 4, v10
  v_xor_b32 v13, 6, v11
  v_lshl_add_u32 v5, v13, 4, v10
  v_mul_u32_u24 v6, 3072, v12
  v_bfe_u32 v10, v1, 2, 2
  v_lshl_add_u32 v6, v10, 7, v6
  v_lshrrev_b32 v10, 1, v10
  v_xor_b32 v10, s55, v10
  v_lshl_add_u32 v6, v10, 6, v6
  v_bfe_u32 v10, v1, 4, 1
  v_lshl_add_u32 v6, v10, 5, v6
  v_and_b32 v10, 3, v1
  v_lshl_add_u32 v6, v10, 3, v6
  v_add_u32 v6, 24576, v6
  s_lshl_b32 s56, s53, 2
  s_lshl_b32 s57, s55, 1
  s_add_u32 s56, s56, s57
  s_lshl_b32 s56, s56, 16
  s_lshl_b32 s57, s52, 1
  s_add_u32 s57, s57, s54
  s_lshl_b32 s57, s57, 10
  s_add_u32 s56, s56, s57
  s_add_u32 s57, s56, 65536
  s_add_u32 s58, s56, 2097152
  s_add_u32 s59, s57, 2097152
  s_add_u32 s60, s56, 4194304
  v_bfe_u32 v8, v1, 4, 1
  v_lshlrev_b32 v8, 16, v8
  v_lshl_add_u32 v8, v12, 8, v8
  v_and_b32 v11, 15, v1
  v_lshl_add_u32 v8, v11, 4, v8
  v_lshlrev_b32 v7, 4, v1
  v_mov_b32 v9, 0x3eb8aa3b
  s_waitcnt lgkmcnt(0)
  s_mov_b32 s32, s26
  s_mov_b32 s33, s27
  s_mov_b32 s34, 16777216
  s_mov_b32 s35, 0x00020000
  s_add_u32 s64, s26, 12615680
  s_addc_u32 s65, s27, 0
  s_load_dwordx2 s[66:67], s[64:65], 0
  s_barrier
  ds_read_b128 v[64:67], v2 offset:0
  ds_read_b64_tr_b16 v[68:69], v6 offset:0
  ds_read_b64_tr_b16 v[70:71], v6 offset:512
  ds_read_b64_tr_b16 v[72:73], v6 offset:1024
  ds_read_b64_tr_b16 v[74:75], v6 offset:1536
  ds_read_b64_tr_b16 v[76:77], v6 offset:2048
  ds_read_b64_tr_b16 v[78:79], v6 offset:2560
  ds_read_b128 v[80:83], v3 offset:0
  ds_read_b64_tr_b16 v[84:85], v6 offset:6144
  ds_read_b64_tr_b16 v[86:87], v6 offset:6656
  ds_read_b64_tr_b16 v[88:89], v6 offset:7168
  ds_read_b64_tr_b16 v[90:91], v6 offset:7680
  ds_read_b64_tr_b16 v[92:93], v6 offset:8192
  ds_read_b64_tr_b16 v[94:95], v6 offset:8704
  s_waitcnt lgkmcnt(0)
  s_barrier
  v_mfma_f32_32x32x16_bf16 v[16:31], v[68:71], v[64:67], 0
  ds_read_b128 v[96:99], v4 offset:0
  ds_read_b64_tr_b16 v[100:101], v6 offset:12288
  ds_read_b64_tr_b16 v[102:103], v6 offset:12800
  ds_read_b64_tr_b16 v[104:105], v6 offset:13312
  v_mfma_f32_32x32x16_bf16 v[32:47], v[72:75], v[64:67], 0
  ds_read_b64_tr_b16 v[106:107], v6 offset:13824
  ds_read_b64_tr_b16 v[108:109], v6 offset:14336
  ds_read_b64_tr_b16 v[110:111], v6 offset:14848
  ds_read_b128 v[112:115], v5 offset:0
  v_mfma_f32_32x32x16_bf16 v[48:63], v[64:67], v[76:79], 0
  ds_read_b64_tr_b16 v[116:117], v6 offset:18432
  ds_read_b64_tr_b16 v[118:119], v6 offset:18944
  ds_read_b64_tr_b16 v[120:121], v6 offset:19456
  v_mfma_f32_32x32x16_bf16 v[16:31], v[84:87], v[80:83], v[16:31]
  ds_read_b64_tr_b16 v[122:123], v6 offset:19968
  ds_read_b64_tr_b16 v[124:125], v6 offset:20480
  ds_read_b64_tr_b16 v[126:127], v6 offset:20992
  v_mfma_f32_32x32x16_bf16 v[32:47], v[88:91], v[80:83], v[32:47]
  v_mfma_f32_32x32x16_bf16 v[48:63], v[80:83], v[92:95], v[48:63]
  s_waitcnt lgkmcnt(0)
  s_barrier
  v_mfma_f32_32x32x16_bf16 v[16:31], v[100:103], v[96:99], v[16:31]
  ds_read_b128 v[64:67], v2 offset:8192
  ds_read_b64_tr_b16 v[68:69], v6 offset:24576
  ds_read_b64_tr_b16 v[70:71], v6 offset:25088
  ds_read_b64_tr_b16 v[72:73], v6 offset:25600
  v_mfma_f32_32x32x16_bf16 v[32:47], v[104:107], v[96:99], v[32:47]
  ds_read_b64_tr_b16 v[74:75], v6 offset:26112
  ds_read_b64_tr_b16 v[76:77], v6 offset:26624
  ds_read_b64_tr_b16 v[78:79], v6 offset:27136
  ds_read_b128 v[80:83], v3 offset:8192
  v_mfma_f32_32x32x16_bf16 v[48:63], v[96:99], v[108:111], v[48:63]
  ds_read_b64_tr_b16 v[84:85], v6 offset:30720
  ds_read_b64_tr_b16 v[86:87], v6 offset:31232
  ds_read_b64_tr_b16 v[88:89], v6 offset:31744
  v_mfma_f32_32x32x16_bf16 v[16:31], v[116:119], v[112:115], v[16:31]
  ds_read_b64_tr_b16 v[90:91], v6 offset:32256
  ds_read_b64_tr_b16 v[92:93], v6 offset:32768
  ds_read_b64_tr_b16 v[94:95], v6 offset:33280
  v_mfma_f32_32x32x16_bf16 v[32:47], v[120:123], v[112:115], v[32:47]
  v_mfma_f32_32x32x16_bf16 v[48:63], v[112:115], v[124:127], v[48:63]
  s_waitcnt lgkmcnt(0)
  s_barrier
  v_mfma_f32_32x32x16_bf16 v[16:31], v[68:71], v[64:67], v[16:31]
  ds_read_b128 v[96:99], v4 offset:8192
  ds_read_b64_tr_b16 v[100:101], v6 offset:36864
  ds_read_b64_tr_b16 v[102:103], v6 offset:37376
  ds_read_b64_tr_b16 v[104:105], v6 offset:37888
  v_mfma_f32_32x32x16_bf16 v[32:47], v[72:75], v[64:67], v[32:47]
  ds_read_b64_tr_b16 v[106:107], v6 offset:38400
  ds_read_b64_tr_b16 v[108:109], v6 offset:38912
  ds_read_b64_tr_b16 v[110:111], v6 offset:39424
  ds_read_b128 v[112:115], v5 offset:8192
  v_mfma_f32_32x32x16_bf16 v[48:63], v[64:67], v[76:79], v[48:63]
  ds_read_b64_tr_b16 v[116:117], v6 offset:43008
  ds_read_b64_tr_b16 v[118:119], v6 offset:43520
  ds_read_b64_tr_b16 v[120:121], v6 offset:44032
  v_mfma_f32_32x32x16_bf16 v[16:31], v[84:87], v[80:83], v[16:31]
  ds_read_b64_tr_b16 v[122:123], v6 offset:44544
  ds_read_b64_tr_b16 v[124:125], v6 offset:45056
  ds_read_b64_tr_b16 v[126:127], v6 offset:45568
  v_mfma_f32_32x32x16_bf16 v[32:47], v[88:91], v[80:83], v[32:47]
  v_mfma_f32_32x32x16_bf16 v[48:63], v[80:83], v[92:95], v[48:63]
  s_waitcnt lgkmcnt(0)
  s_barrier
  v_mfma_f32_32x32x16_bf16 v[16:31], v[100:103], v[96:99], v[16:31]
  ds_read_b128 v[64:67], v2 offset:16384
  ds_read_b64_tr_b16 v[68:69], v6 offset:0
  ds_read_b64_tr_b16 v[70:71], v6 offset:512
  ds_read_b64_tr_b16 v[72:73], v6 offset:1024
  v_mfma_f32_32x32x16_bf16 v[32:47], v[104:107], v[96:99], v[32:47]
  ds_read_b64_tr_b16 v[74:75], v6 offset:1536
  ds_read_b64_tr_b16 v[76:77], v6 offset:2048
  ds_read_b64_tr_b16 v[78:79], v6 offset:2560
  ds_read_b128 v[80:83], v3 offset:16384
  v_mfma_f32_32x32x16_bf16 v[48:63], v[96:99], v[108:111], v[48:63]
  ds_read_b64_tr_b16 v[84:85], v6 offset:6144
  ds_read_b64_tr_b16 v[86:87], v6 offset:6656
  ds_read_b64_tr_b16 v[88:89], v6 offset:7168
  v_mfma_f32_32x32x16_bf16 v[16:31], v[116:119], v[112:115], v[16:31]
  ds_read_b64_tr_b16 v[90:91], v6 offset:7680
  ds_read_b64_tr_b16 v[92:93], v6 offset:8192
  ds_read_b64_tr_b16 v[94:95], v6 offset:8704
  v_mfma_f32_32x32x16_bf16 v[32:47], v[120:123], v[112:115], v[32:47]
  v_mfma_f32_32x32x16_bf16 v[48:63], v[112:115], v[124:127], v[48:63]
  s_waitcnt lgkmcnt(0)
  s_barrier
  v_mfma_f32_32x32x16_bf16 v[16:31], v[68:71], v[64:67], v[16:31]
  ds_read_b128 v[96:99], v4 offset:16384
  ds_read_b64_tr_b16 v[100:101], v6 offset:12288
  ds_read_b64_tr_b16 v[102:103], v6 offset:12800
  ds_read_b64_tr_b16 v[104:105], v6 offset:13312
  v_mfma_f32_32x32x16_bf16 v[32:47], v[72:75], v[64:67], v[32:47]
  ds_read_b64_tr_b16 v[106:107], v6 offset:13824
  ds_read_b64_tr_b16 v[108:109], v6 offset:14336
  ds_read_b64_tr_b16 v[110:111], v6 offset:14848
  ds_read_b128 v[112:115], v5 offset:16384
  v_mfma_f32_32x32x16_bf16 v[48:63], v[64:67], v[76:79], v[48:63]
  ds_read_b64_tr_b16 v[116:117], v6 offset:18432
  ds_read_b64_tr_b16 v[118:119], v6 offset:18944
  ds_read_b64_tr_b16 v[120:121], v6 offset:19456
  v_mfma_f32_32x32x16_bf16 v[16:31], v[84:87], v[80:83], v[16:31]
  ds_read_b64_tr_b16 v[122:123], v6 offset:19968
  ds_read_b64_tr_b16 v[124:125], v6 offset:20480
  ds_read_b64_tr_b16 v[126:127], v6 offset:20992
  v_mfma_f32_32x32x16_bf16 v[32:47], v[88:91], v[80:83], v[32:47]
  v_mfma_f32_32x32x16_bf16 v[48:63], v[80:83], v[92:95], v[48:63]
  s_waitcnt lgkmcnt(0)
  s_barrier
  v_mfma_f32_32x32x16_bf16 v[16:31], v[100:103], v[96:99], v[16:31]
  ds_read_b128 v[64:67], v2 offset:0
  ds_read_b64_tr_b16 v[68:69], v6 offset:24576
  ds_read_b64_tr_b16 v[70:71], v6 offset:25088
  ds_read_b64_tr_b16 v[72:73], v6 offset:25600
  v_mfma_f32_32x32x16_bf16 v[32:47], v[104:107], v[96:99], v[32:47]
  ds_read_b64_tr_b16 v[74:75], v6 offset:26112
  ds_read_b64_tr_b16 v[76:77], v6 offset:26624
  ds_read_b64_tr_b16 v[78:79], v6 offset:27136
  ds_read_b128 v[80:83], v3 offset:0
  v_mfma_f32_32x32x16_bf16 v[48:63], v[96:99], v[108:111], v[48:63]
  ds_read_b64_tr_b16 v[84:85], v6 offset:30720
  ds_read_b64_tr_b16 v[86:87], v6 offset:31232
  ds_read_b64_tr_b16 v[88:89], v6 offset:31744
  v_mfma_f32_32x32x16_bf16 v[16:31], v[116:119], v[112:115], v[16:31]
  ds_read_b64_tr_b16 v[90:91], v6 offset:32256
  ds_read_b64_tr_b16 v[92:93], v6 offset:32768
  ds_read_b64_tr_b16 v[94:95], v6 offset:33280
  v_mfma_f32_32x32x16_bf16 v[32:47], v[120:123], v[112:115], v[32:47]
  v_mfma_f32_32x32x16_bf16 v[48:63], v[112:115], v[124:127], v[48:63]
  s_waitcnt lgkmcnt(0)
  s_barrier
  v_mfma_f32_32x32x16_bf16 v[16:31], v[68:71], v[64:67], v[16:31]
  ds_read_b128 v[96:99], v4 offset:0
  ds_read_b64_tr_b16 v[100:101], v6 offset:36864
  ds_read_b64_tr_b16 v[102:103], v6 offset:37376
  ds_read_b64_tr_b16 v[104:105], v6 offset:37888
  v_mfma_f32_32x32x16_bf16 v[32:47], v[72:75], v[64:67], v[32:47]
  ds_read_b64_tr_b16 v[106:107], v6 offset:38400
  ds_read_b64_tr_b16 v[108:109], v6 offset:38912
  ds_read_b64_tr_b16 v[110:111], v6 offset:39424
  ds_read_b128 v[112:115], v5 offset:0
  v_mfma_f32_32x32x16_bf16 v[48:63], v[64:67], v[76:79], v[48:63]
  ds_read_b64_tr_b16 v[116:117], v6 offset:43008
  ds_read_b64_tr_b16 v[118:119], v6 offset:43520
  ds_read_b64_tr_b16 v[120:121], v6 offset:44032
  v_mfma_f32_32x32x16_bf16 v[16:31], v[84:87], v[80:83], v[16:31]
  ds_read_b64_tr_b16 v[122:123], v6 offset:44544
  ds_read_b64_tr_b16 v[124:125], v6 offset:45056
  ds_read_b64_tr_b16 v[126:127], v6 offset:45568
  v_mfma_f32_32x32x16_bf16 v[32:47], v[88:91], v[80:83], v[32:47]
  v_mfma_f32_32x32x16_bf16 v[48:63], v[80:83], v[92:95], v[48:63]
  s_waitcnt lgkmcnt(0)
  s_barrier
  v_mfma_f32_32x32x16_bf16 v[16:31], v[100:103], v[96:99], v[16:31]
  ds_read_b128 v[64:67], v2 offset:8192
  ds_read_b64_tr_b16 v[68:69], v6 offset:0
  ds_read_b64_tr_b16 v[70:71], v6 offset:512
  ds_read_b64_tr_b16 v[72:73], v6 offset:1024
  v_mfma_f32_32x32x16_bf16 v[32:47], v[104:107], v[96:99], v[32:47]
  ds_read_b64_tr_b16 v[74:75], v6 offset:1536
  ds_read_b64_tr_b16 v[76:77], v6 offset:2048
  ds_read_b64_tr_b16 v[78:79], v6 offset:2560
  ds_read_b128 v[80:83], v3 offset:8192
  v_mfma_f32_32x32x16_bf16 v[48:63], v[96:99], v[108:111], v[48:63]
  ds_read_b64_tr_b16 v[84:85], v6 offset:6144
  ds_read_b64_tr_b16 v[86:87], v6 offset:6656
  ds_read_b64_tr_b16 v[88:89], v6 offset:7168
  v_mfma_f32_32x32x16_bf16 v[16:31], v[116:119], v[112:115], v[16:31]
  ds_read_b64_tr_b16 v[90:91], v6 offset:7680
  ds_read_b64_tr_b16 v[92:93], v6 offset:8192
  ds_read_b64_tr_b16 v[94:95], v6 offset:8704
  v_mfma_f32_32x32x16_bf16 v[32:47], v[120:123], v[112:115], v[32:47]
  v_mfma_f32_32x32x16_bf16 v[48:63], v[112:115], v[124:127], v[48:63]
  s_waitcnt lgkmcnt(0)
  s_barrier
  v_mfma_f32_32x32x16_bf16 v[16:31], v[68:71], v[64:67], v[16:31]
  ds_read_b128 v[96:99], v4 offset:8192
  ds_read_b64_tr_b16 v[100:101], v6 offset:12288
  ds_read_b64_tr_b16 v[102:103], v6 offset:12800
  ds_read_b64_tr_b16 v[104:105], v6 offset:13312
  v_mfma_f32_32x32x16_bf16 v[32:47], v[72:75], v[64:67], v[32:47]
  ds_read_b64_tr_b16 v[106:107], v6 offset:13824
  ds_read_b64_tr_b16 v[108:109], v6 offset:14336
  ds_read_b64_tr_b16 v[110:111], v6 offset:14848
  ds_read_b128 v[112:115], v5 offset:8192
  v_mfma_f32_32x32x16_bf16 v[48:63], v[64:67], v[76:79], v[48:63]
  ds_read_b64_tr_b16 v[116:117], v6 offset:18432
  ds_read_b64_tr_b16 v[118:119], v6 offset:18944
  ds_read_b64_tr_b16 v[120:121], v6 offset:19456
  v_mfma_f32_32x32x16_bf16 v[16:31], v[84:87], v[80:83], v[16:31]
  ds_read_b64_tr_b16 v[122:123], v6 offset:19968
  ds_read_b64_tr_b16 v[124:125], v6 offset:20480
  ds_read_b64_tr_b16 v[126:127], v6 offset:20992
  v_mfma_f32_32x32x16_bf16 v[32:47], v[88:91], v[80:83], v[32:47]
  v_mfma_f32_32x32x16_bf16 v[48:63], v[80:83], v[92:95], v[48:63]
  s_waitcnt lgkmcnt(0)
  s_barrier
  v_mfma_f32_32x32x16_bf16 v[16:31], v[100:103], v[96:99], v[16:31]
  ds_read_b128 v[64:67], v2 offset:16384
  ds_read_b64_tr_b16 v[68:69], v6 offset:24576
  ds_read_b64_tr_b16 v[70:71], v6 offset:25088
  ds_read_b64_tr_b16 v[72:73], v6 offset:25600
  v_mfma_f32_32x32x16_bf16 v[32:47], v[104:107], v[96:99], v[32:47]
  ds_read_b64_tr_b16 v[74:75], v6 offset:26112
  ds_read_b64_tr_b16 v[76:77], v6 offset:26624
  ds_read_b64_tr_b16 v[78:79], v6 offset:27136
  ds_read_b128 v[80:83], v3 offset:16384
  v_mfma_f32_32x32x16_bf16 v[48:63], v[96:99], v[108:111], v[48:63]
  ds_read_b64_tr_b16 v[84:85], v6 offset:30720
  ds_read_b64_tr_b16 v[86:87], v6 offset:31232
  ds_read_b64_tr_b16 v[88:89], v6 offset:31744
  v_mfma_f32_32x32x16_bf16 v[16:31], v[116:119], v[112:115], v[16:31]
  ds_read_b64_tr_b16 v[90:91], v6 offset:32256
  ds_read_b64_tr_b16 v[92:93], v6 offset:32768
  ds_read_b64_tr_b16 v[94:95], v6 offset:33280
  v_mfma_f32_32x32x16_bf16 v[32:47], v[120:123], v[112:115], v[32:47]
  v_mfma_f32_32x32x16_bf16 v[48:63], v[112:115], v[124:127], v[48:63]
  s_waitcnt lgkmcnt(0)
  s_barrier
  v_mfma_f32_32x32x16_bf16 v[16:31], v[68:71], v[64:67], v[16:31]
  ds_read_b128 v[96:99], v4 offset:16384
  ds_read_b64_tr_b16 v[100:101], v6 offset:36864
  ds_read_b64_tr_b16 v[102:103], v6 offset:37376
  ds_read_b64_tr_b16 v[104:105], v6 offset:37888
  v_mfma_f32_32x32x16_bf16 v[32:47], v[72:75], v[64:67], v[32:47]
  ds_read_b64_tr_b16 v[106:107], v6 offset:38400
  ds_read_b64_tr_b16 v[108:109], v6 offset:38912
  ds_read_b64_tr_b16 v[110:111], v6 offset:39424
  ds_read_b128 v[112:115], v5 offset:16384
  v_mfma_f32_32x32x16_bf16 v[48:63], v[64:67], v[76:79], v[48:63]
  ds_read_b64_tr_b16 v[116:117], v6 offset:43008
  ds_read_b64_tr_b16 v[118:119], v6 offset:43520
  ds_read_b64_tr_b16 v[120:121], v6 offset:44032
  v_mfma_f32_32x32x16_bf16 v[16:31], v[84:87], v[80:83], v[16:31]
  ds_read_b64_tr_b16 v[122:123], v6 offset:44544
  ds_read_b64_tr_b16 v[124:125], v6 offset:45056
  ds_read_b64_tr_b16 v[126:127], v6 offset:45568
  v_mfma_f32_32x32x16_bf16 v[32:47], v[88:91], v[80:83], v[32:47]
  v_mfma_f32_32x32x16_bf16 v[48:63], v[80:83], v[92:95], v[48:63]
  s_waitcnt lgkmcnt(0)
  s_barrier
  v_mfma_f32_32x32x16_bf16 v[16:31], v[100:103], v[96:99], v[16:31]
  ds_read_b128 v[64:67], v2 offset:0
  ds_read_b64_tr_b16 v[68:69], v6 offset:0
  ds_read_b64_tr_b16 v[70:71], v6 offset:512
  ds_read_b64_tr_b16 v[72:73], v6 offset:1024
  v_mfma_f32_32x32x16_bf16 v[32:47], v[104:107], v[96:99], v[32:47]
  ds_read_b64_tr_b16 v[74:75], v6 offset:1536
  ds_read_b64_tr_b16 v[76:77], v6 offset:2048
  ds_read_b64_tr_b16 v[78:79], v6 offset:2560
  ds_read_b128 v[80:83], v3 offset:0
  v_mfma_f32_32x32x16_bf16 v[48:63], v[96:99], v[108:111], v[48:63]
  ds_read_b64_tr_b16 v[84:85], v6 offset:6144
  ds_read_b64_tr_b16 v[86:87], v6 offset:6656
  ds_read_b64_tr_b16 v[88:89], v6 offset:7168
  v_mfma_f32_32x32x16_bf16 v[16:31], v[116:119], v[112:115], v[16:31]
  ds_read_b64_tr_b16 v[90:91], v6 offset:7680
  ds_read_b64_tr_b16 v[92:93], v6 offset:8192
  ds_read_b64_tr_b16 v[94:95], v6 offset:8704
  v_mfma_f32_32x32x16_bf16 v[32:47], v[120:123], v[112:115], v[32:47]
  v_mfma_f32_32x32x16_bf16 v[48:63], v[112:115], v[124:127], v[48:63]
  s_waitcnt lgkmcnt(0)
  s_barrier
  v_mfma_f32_32x32x16_bf16 v[16:31], v[68:71], v[64:67], v[16:31]
  ds_read_b128 v[96:99], v4 offset:0
  ds_read_b64_tr_b16 v[100:101], v6 offset:12288
  ds_read_b64_tr_b16 v[102:103], v6 offset:12800
  ds_read_b64_tr_b16 v[104:105], v6 offset:13312
  v_mfma_f32_32x32x16_bf16 v[32:47], v[72:75], v[64:67], v[32:47]
  ds_read_b64_tr_b16 v[106:107], v6 offset:13824
  ds_read_b64_tr_b16 v[108:109], v6 offset:14336
  ds_read_b64_tr_b16 v[110:111], v6 offset:14848
  ds_read_b128 v[112:115], v5 offset:0
  v_mfma_f32_32x32x16_bf16 v[48:63], v[64:67], v[76:79], v[48:63]
  ds_read_b64_tr_b16 v[116:117], v6 offset:18432
  ds_read_b64_tr_b16 v[118:119], v6 offset:18944
  ds_read_b64_tr_b16 v[120:121], v6 offset:19456
  v_mfma_f32_32x32x16_bf16 v[16:31], v[84:87], v[80:83], v[16:31]
  ds_read_b64_tr_b16 v[122:123], v6 offset:19968
  ds_read_b64_tr_b16 v[124:125], v6 offset:20480
  ds_read_b64_tr_b16 v[126:127], v6 offset:20992
  v_mfma_f32_32x32x16_bf16 v[32:47], v[88:91], v[80:83], v[32:47]
  v_mfma_f32_32x32x16_bf16 v[48:63], v[80:83], v[92:95], v[48:63]
  s_waitcnt lgkmcnt(0)
  s_barrier
  v_mfma_f32_32x32x16_bf16 v[16:31], v[100:103], v[96:99], v[16:31]
  ds_read_b128 v[64:67], v2 offset:8192
  ds_read_b64_tr_b16 v[68:69], v6 offset:24576
  ds_read_b64_tr_b16 v[70:71], v6 offset:25088
  ds_read_b64_tr_b16 v[72:73], v6 offset:25600
  v_mfma_f32_32x32x16_bf16 v[32:47], v[104:107], v[96:99], v[32:47]
  ds_read_b64_tr_b16 v[74:75], v6 offset:26112
  ds_read_b64_tr_b16 v[76:77], v6 offset:26624
  ds_read_b64_tr_b16 v[78:79], v6 offset:27136
  ds_read_b128 v[80:83], v3 offset:8192
  v_mfma_f32_32x32x16_bf16 v[48:63], v[96:99], v[108:111], v[48:63]
  ds_read_b64_tr_b16 v[84:85], v6 offset:30720
  ds_read_b64_tr_b16 v[86:87], v6 offset:31232
  ds_read_b64_tr_b16 v[88:89], v6 offset:31744
  v_mfma_f32_32x32x16_bf16 v[16:31], v[116:119], v[112:115], v[16:31]
  ds_read_b64_tr_b16 v[90:91], v6 offset:32256
  ds_read_b64_tr_b16 v[92:93], v6 offset:32768
  ds_read_b64_tr_b16 v[94:95], v6 offset:33280
  v_mfma_f32_32x32x16_bf16 v[32:47], v[120:123], v[112:115], v[32:47]
  v_mfma_f32_32x32x16_bf16 v[48:63], v[112:115], v[124:127], v[48:63]
  s_waitcnt lgkmcnt(0)
  s_barrier
  v_mfma_f32_32x32x16_bf16 v[16:31], v[68:71], v[64:67], v[16:31]
  ds_read_b128 v[96:99], v4 offset:8192
  ds_read_b64_tr_b16 v[100:101], v6 offset:36864
  ds_read_b64_tr_b16 v[102:103], v6 offset:37376
  ds_read_b64_tr_b16 v[104:105], v6 offset:37888
  v_mfma_f32_32x32x16_bf16 v[32:47], v[72:75], v[64:67], v[32:47]
  ds_read_b64_tr_b16 v[106:107], v6 offset:38400
  ds_read_b64_tr_b16 v[108:109], v6 offset:38912
  ds_read_b64_tr_b16 v[110:111], v6 offset:39424
  ds_read_b128 v[112:115], v5 offset:8192
  v_mfma_f32_32x32x16_bf16 v[48:63], v[64:67], v[76:79], v[48:63]
  ds_read_b64_tr_b16 v[116:117], v6 offset:43008
  ds_read_b64_tr_b16 v[118:119], v6 offset:43520
  ds_read_b64_tr_b16 v[120:121], v6 offset:44032
  v_mfma_f32_32x32x16_bf16 v[16:31], v[84:87], v[80:83], v[16:31]
  ds_read_b64_tr_b16 v[122:123], v6 offset:44544
  ds_read_b64_tr_b16 v[124:125], v6 offset:45056
  ds_read_b64_tr_b16 v[126:127], v6 offset:45568
  v_mfma_f32_32x32x16_bf16 v[32:47], v[88:91], v[80:83], v[32:47]
  v_mfma_f32_32x32x16_bf16 v[48:63], v[80:83], v[92:95], v[48:63]
  s_waitcnt lgkmcnt(0)
  v_mfma_f32_32x32x16_bf16 v[16:31], v[100:103], v[96:99], v[16:31]
  v_mfma_f32_32x32x16_bf16 v[32:47], v[104:107], v[96:99], v[32:47]
  v_mfma_f32_32x32x16_bf16 v[48:63], v[96:99], v[108:111], v[48:63]
  v_mfma_f32_32x32x16_bf16 v[16:31], v[116:119], v[112:115], v[16:31]
  v_mfma_f32_32x32x16_bf16 v[32:47], v[120:123], v[112:115], v[32:47]
  v_mfma_f32_32x32x16_bf16 v[48:63], v[112:115], v[124:127], v[48:63]
  s_nop 9
  v_mul_f32 v16, v16, v9
  v_mul_f32 v17, v17, v9
  v_mul_f32 v18, v18, v9
  v_mul_f32 v19, v19, v9
  v_mul_f32 v20, v20, v9
  v_mul_f32 v21, v21, v9
  v_mul_f32 v22, v22, v9
  v_mul_f32 v23, v23, v9
  v_mul_f32 v24, v24, v9
  v_mul_f32 v25, v25, v9
  v_mul_f32 v26, v26, v9
  v_mul_f32 v27, v27, v9
  v_mul_f32 v28, v28, v9
  v_mul_f32 v29, v29, v9
  v_mul_f32 v30, v30, v9
  v_mul_f32 v31, v31, v9
  v_cvt_pk_bf16_f32 v72, v32, v33
  v_cvt_pk_bf16_f32 v73, v34, v35
  v_cvt_pk_bf16_f32 v74, v36, v37
  v_cvt_pk_bf16_f32 v75, v38, v39
  v_cvt_pk_bf16_f32 v76, v40, v41
  v_cvt_pk_bf16_f32 v77, v42, v43
  v_cvt_pk_bf16_f32 v78, v44, v45
  v_cvt_pk_bf16_f32 v79, v46, v47
  v_cvt_pk_bf16_f32 v80, v48, v49
  v_cvt_pk_bf16_f32 v81, v50, v51
  v_cvt_pk_bf16_f32 v82, v52, v53
  v_cvt_pk_bf16_f32 v83, v54, v55
  v_cvt_pk_bf16_f32 v84, v56, v57
  v_cvt_pk_bf16_f32 v85, v58, v59
  v_cvt_pk_bf16_f32 v86, v60, v61
  v_cvt_pk_bf16_f32 v87, v62, v63
  v_cvt_pk_bf16_f32 v64, v16, v17
  v_cvt_pk_bf16_f32 v65, v18, v19
  v_cvt_pk_bf16_f32 v66, v20, v21
  v_cvt_pk_bf16_f32 v67, v22, v23
  v_cvt_pk_bf16_f32 v68, v24, v25
  v_cvt_pk_bf16_f32 v69, v26, v27
  v_cvt_pk_bf16_f32 v70, v28, v29
  v_cvt_pk_bf16_f32 v71, v30, v31
  buffer_store_dwordx4 v[72:75], v7, s[32:35], s58 offen sc1
  buffer_store_dwordx4 v[76:79], v7, s[32:35], s59 offen sc1
  buffer_store_dwordx4 v[80:83], v8, s[32:35], s60 offen sc1
  buffer_store_dwordx4 v[84:87], v8, s[32:35], s60 offen offset:512 sc1
  buffer_store_dwordx4 v[64:67], v7, s[32:35], s56 offen sc1
  buffer_store_dwordx4 v[68:71], v7, s[32:35], s57 offen sc1
  s_barrier
QKV_DONE:
  s_lshl_b32 s61, s53, 5
  s_add_u32 s61, s61, s52
  s_lshl_b32 s61, s61, 7
  s_add_u32 s61, s61, 12648448
  s_and_b32 s48, s2, 7
  s_lshl_b32 s49, s48, 2
  s_bfe_u32 s50, s2, 0x20003
  s_add_u32 s49, s49, s50
  s_lshr_b32 s51, s2, 5
  s_lshl_b32 s52, s51, 3
  s_add_u32 s52, s52, s30
  v_lshlrev_b32 v2, 4, v1
  s_lshl_b32 s53, s49, 16
  s_lshl_b32 s54, s52, 10
  s_add_u32 s54, s54, s53
  s_lshl_b32 s55, s30, 10
  s_add_u32 s56, s53, s55
  s_add_u32 s56, s56, 2097152
  s_lshl_b32 s57, s51, 13
  v_add_u32 v6, s55, v2
  s_mul_i32 s58, s30, 1056
  s_add_u32 s58, s58, 24576
  v_add_u32 v100, s58, v2
  v_mov_b32 v3, v2
  v_lshrrev_b32 v7, 5, v1
  v_lshlrev_b32 v7, 8, v7
  v_and_b32 v4, 15, v1
  v_lshl_add_u32 v4, v4, 4, v7
  v_add_u32 v4, 24576, v4
  v_add_u32 v5, 512, v4
  v_and_b32 v12, 11, v1
  v_cmp_eq_u32 vcc, 0, v12
  v_mov_b32 v7, 25616
  v_mov_b32 v13, 25600
  v_cndmask_b32 v7, v7, v13, vcc
  v_and_b32 v12, 16, v1
  v_cmp_ne_u32 vcc, 0, v12
  s_nop 1
  v_cndmask_b32 v4, v4, v7, vcc
  v_cndmask_b32 v5, v5, v7, vcc
  s_mul_i32 s58, s30, 3
  v_add_u32 v7, s58, v1
  v_mul_u32_u24 v7, 1056, v7
  v_add_u32 v7, 25600, v7
  v_mov_b32 v12, 0x3f803f80
  v_mov_b32 v13, 0x3f803f80
  v_mov_b32 v14, 0x3f803f80
  v_mov_b32 v15, 0x3f803f80
  v_mov_b32 v16, 0
  v_mov_b32 v17, 0
  v_mov_b32 v18, 0
  v_mov_b32 v19, 0
  s_mov_b64 exec, 7
  ds_write_b128 v7, v[12:15]
  ds_write_b128 v7, v[16:19] offset:16
  s_mov_b64 exec, -1
  v_mov_b32 v60, 0
  v_mov_b32 v61, 0
  v_mov_b32 v62, 0
  v_mov_b32 v63, 0
  v_mov_b32 v64, 0
  v_mov_b32 v65, 0
  v_mov_b32 v66, 0
  v_mov_b32 v67, 0
  v_mov_b32 v68, 0
  v_mov_b32 v69, 0
  v_mov_b32 v70, 0
  v_mov_b32 v71, 0
  v_mov_b32 v72, 0
  v_mov_b32 v73, 0
  v_mov_b32 v74, 0
  v_mov_b32 v75, 0
  v_mov_b32 v96, 0
  v_mov_b32 v97, 0
  v_mov_b32 v98, 0
  v_mov_b32 v99, 0
  v_add_u32 v7, s51, v1
  v_and_b32 v7, 7, v7
  v_lshlrev_b32 v7, 9, v7
  s_lshl_b32 s58, s48, 5
  s_lshr_b32 s59, s30, 1
  s_add_u32 s58, s58, s59
  s_lshl_b32 s58, s58, 7
  s_add_u32 s58, s58, 12648448
  s_mov_b32 s36, s26
  s_mov_b32 s37, s27
  s_mov_b32 s38, 16777216
  s_mov_b32 s39, 0x00020000
  s_waitcnt vmcnt(0) lgkmcnt(0)
  s_add_u32 s28, s66, 1
  s_addc_u32 s29, s67, 0
  s_barrier
  s_cmp_lg_u32 s30, 0
  s_cbranch_scc1 PF_q
  v_mov_b32 v120, s28
  v_mov_b32 v121, s29
  v_mov_b32 v122, s28
  v_mov_b32 v123, s29
  v_lshlrev_b32 v124, 4, v1
  s_mov_b64 exec, 0xff
  buffer_store_dwordx4 v[120:123], v124, s[32:35], s61 offen sc1
  s_mov_b64 exec, -1
PF_q:
  s_mov_b32 s71, 20000
  s_mov_b32 exec_lo, 0x1
  s_mov_b32 exec_hi, 0
PL_q0:
  buffer_load_dwordx2 v[36:37], v7, s[32:35], s58 offen sc1
  s_waitcnt vmcnt(0)
  v_cmp_ne_u64 vcc, s[28:29], v[36:37]
  s_cbranch_vccz PD_q0
  s_mov_b64 exec, vcc
  s_sleep 1
  s_sub_u32 s71, s71, 1
  s_cmp_lg_u32 s71, 0
  s_cbranch_scc1 PL_q0
PD_q0:
  s_mov_b64 exec, -1
  s_add_u32 s59, s56, s57
  s_add_u32 s60, s59, 2097152
  buffer_load_dwordx4 v[28:31], v2, s[32:35], s59 offen sc1
  buffer_load_dwordx4 v[32:35], v2, s[32:35], s60 offen sc1
  s_add_u32 s57, s57, 8192
  s_and_b32 s57, s57, 0xffff
  buffer_load_dwordx4 v[8:11], v2, s[32:35], s54 offen sc1
  s_mov_b64 exec, 0xff
  buffer_load_dwordx2 v[36:37], v7, s[32:35], s58 offen sc1
  s_mov_b64 exec, -1
  v_mov_b32 v52, 0
  v_mov_b32 v53, 0
  v_mov_b32 v54, 0
  v_mov_b32 v55, 0
  s_waitcnt vmcnt(2)
  ds_write_b128 v6, v[28:31]
  ds_write_b128 v100, v[32:35]
  v_add_u32 v6, 8192, v6
  v_add_u32 v100, 8448, v100
  s_waitcnt vmcnt(0) lgkmcnt(0)
  s_barrier
  ds_read_b128 v[76:79], v3
  ds_read_b128 v[80:83], v3 offset:1024
  ds_read_b128 v[84:87], v4
  ds_read_b128 v[88:91], v5
  s_mov_b64 exec, 0xff
  v_cmp_ne_u64 vcc, s[28:29], v[36:37]
  s_mov_b64 exec, -1
  s_cbranch_vccz ATT_ALLQ
  s_mov_b32 s71, 20000
  s_mov_b32 exec_lo, 0xff
  s_mov_b32 exec_hi, 0
PL_q:
  buffer_load_dwordx2 v[36:37], v7, s[32:35], s58 offen sc1
  s_waitcnt vmcnt(0)
  v_cmp_ne_u64 vcc, s[28:29], v[36:37]
  s_cbranch_vccz PD_q
  s_mov_b64 exec, vcc
  s_sleep 1
  s_sub_u32 s71, s71, 1
  s_cmp_lg_u32 s71, 0
  s_cbranch_scc1 PL_q
PD_q:
  s_mov_b64 exec, -1
ATT_ALLQ:
  s_add_u32 s59, s56, s57
  s_add_u32 s60, s59, 2097152
  buffer_load_dwordx4 v[104:107], v2, s[32:35], s59 offen sc1
  buffer_load_dwordx4 v[108:111], v2, s[32:35], s60 offen sc1
  s_add_u32 s57, s57, 8192
  s_and_b32 s57, s57, 0xffff
  s_add_u32 s59, s56, s57
  s_add_u32 s60, s59, 2097152
  buffer_load_dwordx4 v[112:115], v2, s[32:35], s59 offen sc1
  buffer_load_dwordx4 v[116:119], v2, s[32:35], s60 offen sc1
  s_add_u32 s57, s57, 8192
  s_and_b32 s57, s57, 0xffff
  s_lshl_b32 s69, s2, 7
  s_add_u32 s69, s69, 12779520
  s_cmp_lg_u32 s30, 4
  s_cbranch_scc1 PF_go
  v_mov_b32 v120, s28
  v_mov_b32 v121, s29
  v_mov_b32 v122, s28
  v_mov_b32 v123, s29
  v_lshlrev_b32 v124, 4, v1
  s_mov_b64 exec, 0xff
  buffer_store_dwordx4 v[120:123], v124, s[32:35], s69 offen sc1
  s_mov_b64 exec, -1
PF_go:
  s_mov_b32 s61, 0
  s_mov_b32 s62, 0
  s_mov_b32 s63, -16384
  s_mov_b32 s64, -16896
  s_waitcnt lgkmcnt(0)
  v_mfma_f32_32x32x16_bf16 v[28:43], v[76:79], v[8:11], 0
  s_nop 11
  v_max3_f32 v7, v28, v29, v30
  v_max3_f32 v7, v7, v31, v32
  v_max3_f32 v7, v7, v33, v34
  v_max3_f32 v7, v7, v35, v36
  v_max3_f32 v7, v7, v37, v38
  v_max3_f32 v7, v7, v39, v40
  v_max3_f32 v7, v7, v41, v42
  v_max_f32 v7, v7, v43
  v_mov_b32 v12, v7
  s_nop 1
  v_permlane32_swap_b32 v7, v12
  v_max_f32 v7, v7, v12
  v_sub_f32 v12, 0, v7
  v_sub_f32 v13, 0, v7
  v_sub_f32 v14, 0, v7
  v_sub_f32 v15, 0, v7
  v_sub_f32 v16, 0, v7
  v_sub_f32 v17, 0, v7
  v_sub_f32 v18, 0, v7
  v_sub_f32 v19, 0, v7
  v_sub_f32 v20, 0, v7
  v_sub_f32 v21, 0, v7
  v_sub_f32 v22, 0, v7
  v_sub_f32 v23, 0, v7
  v_sub_f32 v24, 0, v7
  v_sub_f32 v25, 0, v7
  v_sub_f32 v26, 0, v7
  v_sub_f32 v27, 0, v7
  v_add_f32 v28, v28, v12
  v_add_f32 v29, v29, v12
  v_add_f32 v30, v30, v12
  v_add_f32 v31, v31, v12
  v_add_f32 v32, v32, v12
  v_add_f32 v33, v33, v12
  v_add_f32 v34, v34, v12
  v_add_f32 v35, v35, v12
  v_add_f32 v36, v36, v12
  v_add_f32 v37, v37, v12
  v_add_f32 v38, v38, v12
  v_add_f32 v39, v39, v12
  v_add_f32 v40, v40, v12
  v_add_f32 v41, v41, v12
  v_add_f32 v42, v42, v12
  v_add_f32 v43, v43, v12
  s_setprio 1
.p2align 6
ATT_LOOP:
  v_exp_f32 v28, v28
  v_exp_f32 v29, v29
  v_mfma_f32_32x32x16_bf16 v[60:75], v[96:99], v[52:55], v[60:75]
  s_waitcnt lgkmcnt(0)
  v_exp_f32 v30, v30
  v_exp_f32 v31, v31
  v_exp_f32 v32, v32
  v_exp_f32 v33, v33
  v_mfma_f32_32x32x16_bf16 v[44:59], v[80:83], v[8:11], v[12:27]
  ds_read_b128 v[76:79], v3 offset:2048
  ds_read_b128 v[92:95], v4 offset:1056
  ds_read_b128 v[96:99], v5 offset:1056
  v_exp_f32 v34, v34
  v_exp_f32 v35, v35
  v_cvt_pk_bf16_f32 v28, v28, v29
  v_cvt_pk_bf16_f32 v29, v30, v31
  v_cvt_pk_bf16_f32 v30, v32, v33
  v_cvt_pk_bf16_f32 v31, v34, v35
  v_exp_f32 v36, v36
  v_exp_f32 v37, v37
  v_mfma_f32_32x32x16_bf16 v[60:75], v[84:87], v[28:31], v[60:75]
  s_cmp_eq_u32 s62, 2
  s_cselect_b32 s65, s63, 8192
  s_cselect_b32 s66, s64, 8448
  v_exp_f32 v38, v38
  v_exp_f32 v39, v39
  v_exp_f32 v40, v40
  v_exp_f32 v41, v41
  v_exp_f32 v42, v42
  v_exp_f32 v43, v43
  v_cvt_pk_bf16_f32 v36, v36, v37
  v_cvt_pk_bf16_f32 v37, v38, v39
  v_cvt_pk_bf16_f32 v38, v40, v41
  v_cvt_pk_bf16_f32 v39, v42, v43
  v_exp_f32 v44, v44
  v_exp_f32 v45, v45
  v_mfma_f32_32x32x16_bf16 v[60:75], v[88:91], v[36:39], v[60:75]
  s_waitcnt lgkmcnt(0)
  v_exp_f32 v46, v46
  v_exp_f32 v47, v47
  v_exp_f32 v48, v48
  v_exp_f32 v49, v49
  v_mfma_f32_32x32x16_bf16 v[28:43], v[76:79], v[8:11], v[12:27]
  ds_read_b128 v[80:83], v3 offset:3072
  ds_read_b128 v[84:87], v4 offset:2112
  ds_read_b128 v[88:91], v5 offset:2112
  v_exp_f32 v50, v50
  v_exp_f32 v51, v51
  v_cvt_pk_bf16_f32 v44, v44, v45
  v_cvt_pk_bf16_f32 v45, v46, v47
  v_cvt_pk_bf16_f32 v46, v48, v49
  v_cvt_pk_bf16_f32 v47, v50, v51
  v_exp_f32 v52, v52
  v_exp_f32 v53, v53
  v_mfma_f32_32x32x16_bf16 v[60:75], v[92:95], v[44:47], v[60:75]
  s_cmp_eq_u32 s62, 1
  s_cselect_b32 s67, s63, 8192
  s_cselect_b32 s68, s64, 8448
  v_exp_f32 v54, v54
  v_exp_f32 v55, v55
  v_exp_f32 v56, v56
  v_exp_f32 v57, v57
  v_exp_f32 v58, v58
  v_exp_f32 v59, v59
  v_cvt_pk_bf16_f32 v52, v52, v53
  v_cvt_pk_bf16_f32 v53, v54, v55
  v_cvt_pk_bf16_f32 v54, v56, v57
  v_cvt_pk_bf16_f32 v55, v58, v59
  v_exp_f32 v28, v28
  v_exp_f32 v29, v29
  v_mfma_f32_32x32x16_bf16 v[60:75], v[96:99], v[52:55], v[60:75]
  s_waitcnt lgkmcnt(0)
  v_exp_f32 v30, v30
  v_exp_f32 v31, v31
  v_exp_f32 v32, v32
  v_exp_f32 v33, v33
  v_mfma_f32_32x32x16_bf16 v[44:59], v[80:83], v[8:11], v[12:27]
  ds_read_b128 v[76:79], v3 offset:4096
  ds_read_b128 v[92:95], v4 offset:3168
  ds_read_b128 v[96:99], v5 offset:3168
  v_exp_f32 v34, v34
  v_exp_f32 v35, v35
  v_cvt_pk_bf16_f32 v28, v28, v29
  v_cvt_pk_bf16_f32 v29, v30, v31
  v_cvt_pk_bf16_f32 v30, v32, v33
  v_cvt_pk_bf16_f32 v31, v34, v35
  v_exp_f32 v36, v36
  v_exp_f32 v37, v37
  v_mfma_f32_32x32x16_bf16 v[60:75], v[84:87], v[28:31], v[60:75]
  v_exp_f32 v38, v38
  v_exp_f32 v39, v39
  v_exp_f32 v40, v40
  v_exp_f32 v41, v41
  v_exp_f32 v42, v42
  v_exp_f32 v43, v43
  v_cvt_pk_bf16_f32 v36, v36, v37
  v_cvt_pk_bf16_f32 v37, v38, v39
  v_cvt_pk_bf16_f32 v38, v40, v41
  v_cvt_pk_bf16_f32 v39, v42, v43
  v_exp_f32 v44, v44
  v_exp_f32 v45, v45
  v_mfma_f32_32x32x16_bf16 v[60:75], v[88:91], v[36:39], v[60:75]
  s_waitcnt lgkmcnt(0)
  v_exp_f32 v46, v46
  v_exp_f32 v47, v47
  v_exp_f32 v48, v48
  v_exp_f32 v49, v49
  v_mfma_f32_32x32x16_bf16 v[28:43], v[76:79], v[8:11], v[12:27]
  ds_read_b128 v[80:83], v3 offset:5120
  ds_read_b128 v[84:87], v4 offset:4224
  ds_read_b128 v[88:91], v5 offset:4224
  v_exp_f32 v50, v50
  v_exp_f32 v51, v51
  v_cvt_pk_bf16_f32 v44, v44, v45
  v_cvt_pk_bf16_f32 v45, v46, v47
  v_cvt_pk_bf16_f32 v46, v48, v49
  v_cvt_pk_bf16_f32 v47, v50, v51
  v_exp_f32 v52, v52
  v_exp_f32 v53, v53
  v_mfma_f32_32x32x16_bf16 v[60:75], v[92:95], v[44:47], v[60:75]
  s_waitcnt vmcnt(2)
  ds_write_b128 v6, v[104:107]
  ds_write_b128 v100, v[108:111]
  v_exp_f32 v54, v54
  v_exp_f32 v55, v55
  v_exp_f32 v56, v56
  v_exp_f32 v57, v57
  v_exp_f32 v58, v58
  v_exp_f32 v59, v59
  v_cvt_pk_bf16_f32 v52, v52, v53
  v_cvt_pk_bf16_f32 v53, v54, v55
  v_cvt_pk_bf16_f32 v54, v56, v57
  v_cvt_pk_bf16_f32 v55, v58, v59
  v_exp_f32 v28, v28
  v_exp_f32 v29, v29
  v_mfma_f32_32x32x16_bf16 v[60:75], v[96:99], v[52:55], v[60:75]
  s_waitcnt lgkmcnt(0)
  s_setprio 0
  v_exp_f32 v30, v30
  v_exp_f32 v31, v31
  v_exp_f32 v32, v32
  v_exp_f32 v33, v33
  v_mfma_f32_32x32x16_bf16 v[44:59], v[80:83], v[8:11], v[12:27]
  ds_read_b128 v[76:79], v3 offset:6144
  ds_read_b128 v[92:95], v4 offset:5280
  ds_read_b128 v[96:99], v5 offset:5280
  v_exp_f32 v34, v34
  v_exp_f32 v35, v35
  v_cvt_pk_bf16_f32 v28, v28, v29
  v_cvt_pk_bf16_f32 v29, v30, v31
  v_cvt_pk_bf16_f32 v30, v32, v33
  v_cvt_pk_bf16_f32 v31, v34, v35
  v_exp_f32 v36, v36
  v_exp_f32 v37, v37
  v_mfma_f32_32x32x16_bf16 v[60:75], v[84:87], v[28:31], v[60:75]
  s_cmp_ge_u32 s61, 5
  s_cselect_b32 s38, 0, s38
  s_add_u32 s59, s56, s57
  s_add_u32 s60, s59, 2097152
  buffer_load_dwordx4 v[104:107], v2, s[36:39], s59 offen sc1
  buffer_load_dwordx4 v[108:111], v2, s[36:39], s60 offen sc1
  s_add_u32 s57, s57, 8192
  s_and_b32 s57, s57, 0xffff
  v_exp_f32 v38, v38
  v_exp_f32 v39, v39
  v_exp_f32 v40, v40
  v_exp_f32 v41, v41
  v_exp_f32 v42, v42
  v_exp_f32 v43, v43
  v_cvt_pk_bf16_f32 v36, v36, v37
  v_cvt_pk_bf16_f32 v37, v38, v39
  v_cvt_pk_bf16_f32 v38, v40, v41
  v_cvt_pk_bf16_f32 v39, v42, v43
  v_exp_f32 v44, v44
  v_exp_f32 v45, v45
  v_mfma_f32_32x32x16_bf16 v[60:75], v[88:91], v[36:39], v[60:75]
  s_waitcnt lgkmcnt(0)
  s_barrier
  s_setprio 1
  v_exp_f32 v46, v46
  v_exp_f32 v47, v47
  v_exp_f32 v48, v48
  v_exp_f32 v49, v49
  v_mfma_f32_32x32x16_bf16 v[28:43], v[76:79], v[8:11], v[12:27]
  ds_read_b128 v[80:83], v3 offset:7168
  ds_read_b128 v[84:87], v4 offset:6336
  ds_read_b128 v[88:91], v5 offset:6336
  v_exp_f32 v50, v50
  v_exp_f32 v51, v51
  v_cvt_pk_bf16_f32 v44, v44, v45
  v_cvt_pk_bf16_f32 v45, v46, v47
  v_cvt_pk_bf16_f32 v46, v48, v49
  v_cvt_pk_bf16_f32 v47, v50, v51
  v_exp_f32 v52, v52
  v_exp_f32 v53, v53
  v_mfma_f32_32x32x16_bf16 v[60:75], v[92:95], v[44:47], v[60:75]
  v_add_u32 v6, s67, v6
  v_add_u32 v100, s68, v100
  s_add_u32 s62, s62, 1
  s_cmp_eq_u32 s62, 3
  s_cselect_b32 s62, 0, s62
  v_exp_f32 v54, v54
  v_exp_f32 v55, v55
  v_exp_f32 v56, v56
  v_exp_f32 v57, v57
  v_exp_f32 v58, v58
  v_exp_f32 v59, v59
  v_cvt_pk_bf16_f32 v52, v52, v53
  v_cvt_pk_bf16_f32 v53, v54, v55
  v_cvt_pk_bf16_f32 v54, v56, v57
  v_cvt_pk_bf16_f32 v55, v58, v59
  v_exp_f32 v28, v28
  v_exp_f32 v29, v29
  v_mfma_f32_32x32x16_bf16 v[60:75], v[96:99], v[52:55], v[60:75]
  s_waitcnt lgkmcnt(0)
  v_exp_f32 v30, v30
  v_exp_f32 v31, v31
  v_exp_f32 v32, v32
  v_exp_f32 v33, v33
  v_mfma_f32_32x32x16_bf16 v[44:59], v[80:83], v[8:11], v[12:27]
  v_add_u32 v3, s65, v3
  ds_read_b128 v[76:79], v3 offset:0
  ds_read_b128 v[92:95], v4 offset:7392
  ds_read_b128 v[96:99], v5 offset:7392
  v_exp_f32 v34, v34
  v_exp_f32 v35, v35
  v_cvt_pk_bf16_f32 v28, v28, v29
  v_cvt_pk_bf16_f32 v29, v30, v31
  v_cvt_pk_bf16_f32 v30, v32, v33
  v_cvt_pk_bf16_f32 v31, v34, v35
  v_exp_f32 v36, v36
  v_exp_f32 v37, v37
  v_mfma_f32_32x32x16_bf16 v[60:75], v[84:87], v[28:31], v[60:75]
  v_exp_f32 v38, v38
  v_exp_f32 v39, v39
  v_exp_f32 v40, v40
  v_exp_f32 v41, v41
  v_exp_f32 v42, v42
  v_exp_f32 v43, v43
  v_cvt_pk_bf16_f32 v36, v36, v37
  v_cvt_pk_bf16_f32 v37, v38, v39
  v_cvt_pk_bf16_f32 v38, v40, v41
  v_cvt_pk_bf16_f32 v39, v42, v43
  v_exp_f32 v44, v44
  v_exp_f32 v45, v45
  v_mfma_f32_32x32x16_bf16 v[60:75], v[88:91], v[36:39], v[60:75]
  s_waitcnt lgkmcnt(0)
  v_exp_f32 v46, v46
  v_exp_f32 v47, v47
  v_exp_f32 v48, v48
  v_exp_f32 v49, v49
  v_mfma_f32_32x32x16_bf16 v[28:43], v[76:79], v[8:11], v[12:27]
  v_add_u32 v4, s66, v4
  v_add_u32 v5, s66, v5
  ds_read_b128 v[80:83], v3 offset:1024
  ds_read_b128 v[84:87], v4 offset:0
  ds_read_b128 v[88:91], v5 offset:0
  v_exp_f32 v50, v50
  v_exp_f32 v51, v51
  v_cvt_pk_bf16_f32 v44, v44, v45
  v_cvt_pk_bf16_f32 v45, v46, v47
  v_cvt_pk_bf16_f32 v46, v48, v49
  v_cvt_pk_bf16_f32 v47, v50, v51
  v_exp_f32 v52, v52
  v_exp_f32 v53, v53
  v_mfma_f32_32x32x16_bf16 v[60:75], v[92:95], v[44:47], v[60:75]
  s_add_u32 s61, s61, 1
  s_cmp_lt_u32 s61, 8
  v_exp_f32 v54, v54
  v_exp_f32 v55, v55
  v_exp_f32 v56, v56
  v_exp_f32 v57, v57
  v_exp_f32 v58, v58
  v_exp_f32 v59, v59
  v_cvt_pk_bf16_f32 v52, v52, v53
  v_cvt_pk_bf16_f32 v53, v54, v55
  v_cvt_pk_bf16_f32 v54, v56, v57
  v_cvt_pk_bf16_f32 v55, v58, v59
  v_exp_f32 v28, v28
  v_exp_f32 v29, v29
  v_mfma_f32_32x32x16_bf16 v[60:75], v[96:99], v[52:55], v[60:75]
  s_waitcnt lgkmcnt(0)
  v_exp_f32 v30, v30
  v_exp_f32 v31, v31
  v_exp_f32 v32, v32
  v_exp_f32 v33, v33
  v_mfma_f32_32x32x16_bf16 v[44:59], v[80:83], v[8:11], v[12:27]
  ds_read_b128 v[76:79], v3 offset:2048
  ds_read_b128 v[92:95], v4 offset:1056
  ds_read_b128 v[96:99], v5 offset:1056
  v_exp_f32 v34, v34
  v_exp_f32 v35, v35
  v_cvt_pk_bf16_f32 v28, v28, v29
  v_cvt_pk_bf16_f32 v29, v30, v31
  v_cvt_pk_bf16_f32 v30, v32, v33
  v_cvt_pk_bf16_f32 v31, v34, v35
  v_exp_f32 v36, v36
  v_exp_f32 v37, v37
  v_mfma_f32_32x32x16_bf16 v[60:75], v[84:87], v[28:31], v[60:75]
  s_cmp_eq_u32 s62, 2
  s_cselect_b32 s65, s63, 8192
  s_cselect_b32 s66, s64, 8448
  v_exp_f32 v38, v38
  v_exp_f32 v39, v39
  v_exp_f32 v40, v40
  v_exp_f32 v41, v41
  v_exp_f32 v42, v42
  v_exp_f32 v43, v43
  v_cvt_pk_bf16_f32 v36, v36, v37
  v_cvt_pk_bf16_f32 v37, v38, v39
  v_cvt_pk_bf16_f32 v38, v40, v41
  v_cvt_pk_bf16_f32 v39, v42, v43
  v_exp_f32 v44, v44
  v_exp_f32 v45, v45
  v_mfma_f32_32x32x16_bf16 v[60:75], v[88:91], v[36:39], v[60:75]
  s_waitcnt lgkmcnt(0)
  v_exp_f32 v46, v46
  v_exp_f32 v47, v47
  v_exp_f32 v48, v48
  v_exp_f32 v49, v49
  v_mfma_f32_32x32x16_bf16 v[28:43], v[76:79], v[8:11], v[12:27]
  ds_read_b128 v[80:83], v3 offset:3072
  ds_read_b128 v[84:87], v4 offset:2112
  ds_read_b128 v[88:91], v5 offset:2112
  v_exp_f32 v50, v50
  v_exp_f32 v51, v51
  v_cvt_pk_bf16_f32 v44, v44, v45
  v_cvt_pk_bf16_f32 v45, v46, v47
  v_cvt_pk_bf16_f32 v46, v48, v49
  v_cvt_pk_bf16_f32 v47, v50, v51
  v_exp_f32 v52, v52
  v_exp_f32 v53, v53
  v_mfma_f32_32x32x16_bf16 v[60:75], v[92:95], v[44:47], v[60:75]
  s_cmp_eq_u32 s62, 1
  s_cselect_b32 s67, s63, 8192
  s_cselect_b32 s68, s64, 8448
  v_exp_f32 v54, v54
  v_exp_f32 v55, v55
  v_exp_f32 v56, v56
  v_exp_f32 v57, v57
  v_exp_f32 v58, v58
  v_exp_f32 v59, v59
  v_cvt_pk_bf16_f32 v52, v52, v53
  v_cvt_pk_bf16_f32 v53, v54, v55
  v_cvt_pk_bf16_f32 v54, v56, v57
  v_cvt_pk_bf16_f32 v55, v58, v59
  v_exp_f32 v28, v28
  v_exp_f32 v29, v29
  v_mfma_f32_32x32x16_bf16 v[60:75], v[96:99], v[52:55], v[60:75]
  s_waitcnt lgkmcnt(0)
  v_exp_f32 v30, v30
  v_exp_f32 v31, v31
  v_exp_f32 v32, v32
  v_exp_f32 v33, v33
  v_mfma_f32_32x32x16_bf16 v[44:59], v[80:83], v[8:11], v[12:27]
  ds_read_b128 v[76:79], v3 offset:4096
  ds_read_b128 v[92:95], v4 offset:3168
  ds_read_b128 v[96:99], v5 offset:3168
  v_exp_f32 v34, v34
  v_exp_f32 v35, v35
  v_cvt_pk_bf16_f32 v28, v28, v29
  v_cvt_pk_bf16_f32 v29, v30, v31
  v_cvt_pk_bf16_f32 v30, v32, v33
  v_cvt_pk_bf16_f32 v31, v34, v35
  v_exp_f32 v36, v36
  v_exp_f32 v37, v37
  v_mfma_f32_32x32x16_bf16 v[60:75], v[84:87], v[28:31], v[60:75]
  v_exp_f32 v38, v38
  v_exp_f32 v39, v39
  v_exp_f32 v40, v40
  v_exp_f32 v41, v41
  v_exp_f32 v42, v42
  v_exp_f32 v43, v43
  v_cvt_pk_bf16_f32 v36, v36, v37
  v_cvt_pk_bf16_f32 v37, v38, v39
  v_cvt_pk_bf16_f32 v38, v40, v41
  v_cvt_pk_bf16_f32 v39, v42, v43
  v_exp_f32 v44, v44
  v_exp_f32 v45, v45
  v_mfma_f32_32x32x16_bf16 v[60:75], v[88:91], v[36:39], v[60:75]
  s_waitcnt lgkmcnt(0)
  v_exp_f32 v46, v46
  v_exp_f32 v47, v47
  v_exp_f32 v48, v48
  v_exp_f32 v49, v49
  v_mfma_f32_32x32x16_bf16 v[28:43], v[76:79], v[8:11], v[12:27]
  ds_read_b128 v[80:83], v3 offset:5120
  ds_read_b128 v[84:87], v4 offset:4224
  ds_read_b128 v[88:91], v5 offset:4224
  v_exp_f32 v50, v50
  v_exp_f32 v51, v51
  v_cvt_pk_bf16_f32 v44, v44, v45
  v_cvt_pk_bf16_f32 v45, v46, v47
  v_cvt_pk_bf16_f32 v46, v48, v49
  v_cvt_pk_bf16_f32 v47, v50, v51
  v_exp_f32 v52, v52
  v_exp_f32 v53, v53
  v_mfma_f32_32x32x16_bf16 v[60:75], v[92:95], v[44:47], v[60:75]
  s_waitcnt vmcnt(2)
  ds_write_b128 v6, v[112:115]
  ds_write_b128 v100, v[116:119]
  v_exp_f32 v54, v54
  v_exp_f32 v55, v55
  v_exp_f32 v56, v56
  v_exp_f32 v57, v57
  v_exp_f32 v58, v58
  v_exp_f32 v59, v59
  v_cvt_pk_bf16_f32 v52, v52, v53
  v_cvt_pk_bf16_f32 v53, v54, v55
  v_cvt_pk_bf16_f32 v54, v56, v57
  v_cvt_pk_bf16_f32 v55, v58, v59
  v_exp_f32 v28, v28
  v_exp_f32 v29, v29
  v_mfma_f32_32x32x16_bf16 v[60:75], v[96:99], v[52:55], v[60:75]
  s_waitcnt lgkmcnt(0)
  s_setprio 0
  v_exp_f32 v30, v30
  v_exp_f32 v31, v31
  v_exp_f32 v32, v32
  v_exp_f32 v33, v33
  v_mfma_f32_32x32x16_bf16 v[44:59], v[80:83], v[8:11], v[12:27]
  ds_read_b128 v[76:79], v3 offset:6144
  ds_read_b128 v[92:95], v4 offset:5280
  ds_read_b128 v[96:99], v5 offset:5280
  v_exp_f32 v34, v34
  v_exp_f32 v35, v35
  v_cvt_pk_bf16_f32 v28, v28, v29
  v_cvt_pk_bf16_f32 v29, v30, v31
  v_cvt_pk_bf16_f32 v30, v32, v33
  v_cvt_pk_bf16_f32 v31, v34, v35
  v_exp_f32 v36, v36
  v_exp_f32 v37, v37
  v_mfma_f32_32x32x16_bf16 v[60:75], v[84:87], v[28:31], v[60:75]
  s_cmp_ge_u32 s61, 5
  s_cselect_b32 s38, 0, s38
  s_add_u32 s59, s56, s57
  s_add_u32 s60, s59, 2097152
  buffer_load_dwordx4 v[112:115], v2, s[36:39], s59 offen sc1
  buffer_load_dwordx4 v[116:119], v2, s[36:39], s60 offen sc1
  s_add_u32 s57, s57, 8192
  s_and_b32 s57, s57, 0xffff
  v_exp_f32 v38, v38
  v_exp_f32 v39, v39
  v_exp_f32 v40, v40
  v_exp_f32 v41, v41
  v_exp_f32 v42, v42
  v_exp_f32 v43, v43
  v_cvt_pk_bf16_f32 v36, v36, v37
  v_cvt_pk_bf16_f32 v37, v38, v39
  v_cvt_pk_bf16_f32 v38, v40, v41
  v_cvt_pk_bf16_f32 v39, v42, v43
  v_exp_f32 v44, v44
  v_exp_f32 v45, v45
  v_mfma_f32_32x32x16_bf16 v[60:75], v[88:91], v[36:39], v[60:75]
  s_waitcnt lgkmcnt(0)
  s_barrier
  s_setprio 1
  v_exp_f32 v46, v46
  v_exp_f32 v47, v47
  v_exp_f32 v48, v48
  v_exp_f32 v49, v49
  v_mfma_f32_32x32x16_bf16 v[28:43], v[76:79], v[8:11], v[12:27]
  ds_read_b128 v[80:83], v3 offset:7168
  ds_read_b128 v[84:87], v4 offset:6336
  ds_read_b128 v[88:91], v5 offset:6336
  v_exp_f32 v50, v50
  v_exp_f32 v51, v51
  v_cvt_pk_bf16_f32 v44, v44, v45
  v_cvt_pk_bf16_f32 v45, v46, v47
  v_cvt_pk_bf16_f32 v46, v48, v49
  v_cvt_pk_bf16_f32 v47, v50, v51
  v_exp_f32 v52, v52
  v_exp_f32 v53, v53
  v_mfma_f32_32x32x16_bf16 v[60:75], v[92:95], v[44:47], v[60:75]
  v_add_u32 v6, s67, v6
  v_add_u32 v100, s68, v100
  s_add_u32 s62, s62, 1
  s_cmp_eq_u32 s62, 3
  s_cselect_b32 s62, 0, s62
  v_exp_f32 v54, v54
  v_exp_f32 v55, v55
  v_exp_f32 v56, v56
  v_exp_f32 v57, v57
  v_exp_f32 v58, v58
  v_exp_f32 v59, v59
  v_cvt_pk_bf16_f32 v52, v52, v53
  v_cvt_pk_bf16_f32 v53, v54, v55
  v_cvt_pk_bf16_f32 v54, v56, v57
  v_cvt_pk_bf16_f32 v55, v58, v59
  v_exp_f32 v28, v28
  v_exp_f32 v29, v29
  v_mfma_f32_32x32x16_bf16 v[60:75], v[96:99], v[52:55], v[60:75]
  s_waitcnt lgkmcnt(0)
  v_exp_f32 v30, v30
  v_exp_f32 v31, v31
  v_exp_f32 v32, v32
  v_exp_f32 v33, v33
  v_mfma_f32_32x32x16_bf16 v[44:59], v[80:83], v[8:11], v[12:27]
  v_add_u32 v3, s65, v3
  ds_read_b128 v[76:79], v3 offset:0
  ds_read_b128 v[92:95], v4 offset:7392
  ds_read_b128 v[96:99], v5 offset:7392
  v_exp_f32 v34, v34
  v_exp_f32 v35, v35
  v_cvt_pk_bf16_f32 v28, v28, v29
  v_cvt_pk_bf16_f32 v29, v30, v31
  v_cvt_pk_bf16_f32 v30, v32, v33
  v_cvt_pk_bf16_f32 v31, v34, v35
  v_exp_f32 v36, v36
  v_exp_f32 v37, v37
  v_mfma_f32_32x32x16_bf16 v[60:75], v[84:87], v[28:31], v[60:75]
  v_exp_f32 v38, v38
  v_exp_f32 v39, v39
  v_exp_f32 v40, v40
  v_exp_f32 v41, v41
  v_exp_f32 v42, v42
  v_exp_f32 v43, v43
  v_cvt_pk_bf16_f32 v36, v36, v37
  v_cvt_pk_bf16_f32 v37, v38, v39
  v_cvt_pk_bf16_f32 v38, v40, v41
  v_cvt_pk_bf16_f32 v39, v42, v43
  v_exp_f32 v44, v44
  v_exp_f32 v45, v45
  v_mfma_f32_32x32x16_bf16 v[60:75], v[88:91], v[36:39], v[60:75]
  s_waitcnt lgkmcnt(0)
  v_exp_f32 v46, v46
  v_exp_f32 v47, v47
  v_exp_f32 v48, v48
  v_exp_f32 v49, v49
  v_mfma_f32_32x32x16_bf16 v[28:43], v[76:79], v[8:11], v[12:27]
  v_add_u32 v4, s66, v4
  v_add_u32 v5, s66, v5
  ds_read_b128 v[80:83], v3 offset:1024
  ds_read_b128 v[84:87], v4 offset:0
  ds_read_b128 v[88:91], v5 offset:0
  v_exp_f32 v50, v50
  v_exp_f32 v51, v51
  v_cvt_pk_bf16_f32 v44, v44, v45
  v_cvt_pk_bf16_f32 v45, v46, v47
  v_cvt_pk_bf16_f32 v46, v48, v49
  v_cvt_pk_bf16_f32 v47, v50, v51
  v_exp_f32 v52, v52
  v_exp_f32 v53, v53
  v_mfma_f32_32x32x16_bf16 v[60:75], v[92:95], v[44:47], v[60:75]
  s_add_u32 s61, s61, 1
  s_cmp_lt_u32 s61, 8
  v_exp_f32 v54, v54
  v_exp_f32 v55, v55
  v_exp_f32 v56, v56
  v_exp_f32 v57, v57
  v_exp_f32 v58, v58
  v_exp_f32 v59, v59
  v_cvt_pk_bf16_f32 v52, v52, v53
  v_cvt_pk_bf16_f32 v53, v54, v55
  v_cvt_pk_bf16_f32 v54, v56, v57
  v_cvt_pk_bf16_f32 v55, v58, v59
  s_cbranch_scc1 ATT_LOOP
  s_nop 0
  v_mfma_f32_32x32x16_bf16 v[60:75], v[96:99], v[52:55], v[60:75]
  s_lshr_b32 s58, s52, 1
  s_lshl_b32 s58, s58, 16
  s_lshl_b32 s59, s49, 11
  s_add_u32 s58, s58, s59
  s_and_b32 s59, s52, 1
  s_lshl_b32 s59, s59, 10
  s_add_u32 s58, s58, s59
  s_add_u32 s58, s58, 10485760
  s_lshl_b32 s59, s52, 5
  s_add_u32 s59, s59, s49
  s_lshl_b32 s59, s59, 7
  s_add_u32 s59, s59, 12845056
  s_waitcnt vmcnt(0) lgkmcnt(0)
  v_add_f32 v7, |v60|, |v61|
  v_add_f32 v7, v7, |v62|
  v_add_f32 v7, v7, |v63|
  v_add_f32 v7, v7, |v64|
  v_add_f32 v7, v7, |v65|
  v_add_f32 v7, v7, |v66|
  v_add_f32 v7, v7, |v67|
  v_mov_b32 v28, 0x5d800000
  v_mov_b32 v29, 0x7f61b1e6
  v_cmp_nle_f32 vcc, v68, v28
  v_cmp_nle_f32 s[68:69], v7, v29
  s_nop 0
  s_or_b64 vcc, vcc, s[68:69]
  s_cbranch_vccnz ATT_SLOW
ATT_FIN:
  s_nop 7
  v_rcp_f32 v7, v68
  s_nop 0
  v_mul_f32 v60, v60, v7
  v_mul_f32 v61, v61, v7
  v_mul_f32 v62, v62, v7
  v_mul_f32 v63, v63, v7
  v_mul_f32 v64, v64, v7
  v_mul_f32 v65, v65, v7
  v_mul_f32 v66, v66, v7
  v_mul_f32 v67, v67, v7
  v_cvt_pk_bf16_f32 v28, v60, v61
  v_cvt_pk_bf16_f32 v29, v62, v63
  v_cvt_pk_bf16_f32 v30, v64, v65
  v_cvt_pk_bf16_f32 v31, v66, v67
  buffer_store_dwordx4 v[28:31], v2, s[32:35], s58 offen sc1
  s_waitcnt vmcnt(0)
  v_mov_b32 v8, s28
  v_mov_b32 v9, s29
  v_mov_b32 v10, s28
  v_mov_b32 v11, s29
  v_lshlrev_b32 v12, 4, v1
  s_mov_b64 exec, 0xff
  buffer_store_dwordx4 v[8:11], v12, s[32:35], s59 offen sc1
  s_mov_b64 exec, -1
PF_o:
  s_endpgm
ATT_SLOW:
  s_add_u32 s56, s53, 2097152
  v_mov_b32 v60, 0xff800000
  s_mov_b32 s61, 0
ATT_S1:
  buffer_load_dwordx4 v[76:79], v2, s[32:35], s56 offen sc1
  s_add_u32 s56, s56, 1024
  s_waitcnt vmcnt(0)
  v_mfma_f32_32x32x16_bf16 v[28:43], v[76:79], v[8:11], 0
  s_nop 11
  v_max3_f32 v7, v28, v29, v30
  v_max3_f32 v7, v7, v31, v32
  v_max3_f32 v7, v7, v33, v34
  v_max3_f32 v7, v7, v35, v36
  v_max3_f32 v7, v7, v37, v38
  v_max3_f32 v7, v7, v39, v40
  v_max3_f32 v7, v7, v41, v42
  v_max_f32 v7, v7, v43
  v_max_f32 v60, v60, v7
  s_add_u32 s61, s61, 1
  s_cmp_lt_u32 s61, 64
  s_cbranch_scc1 ATT_S1
  v_mov_b32 v7, v60
  v_mov_b32 v12, v7
  s_nop 1
  v_permlane32_swap_b32 v7, v12
  v_max_f32 v7, v7, v12
  v_sub_f32 v12, 0, v7
  v_sub_f32 v13, 0, v7
  v_sub_f32 v14, 0, v7
  v_sub_f32 v15, 0, v7
  v_sub_f32 v16, 0, v7
  v_sub_f32 v17, 0, v7
  v_sub_f32 v18, 0, v7
  v_sub_f32 v19, 0, v7
  v_sub_f32 v20, 0, v7
  v_sub_f32 v21, 0, v7
  v_sub_f32 v22, 0, v7
  v_sub_f32 v23, 0, v7
  v_sub_f32 v24, 0, v7
  v_sub_f32 v25, 0, v7
  v_sub_f32 v26, 0, v7
  v_sub_f32 v27, 0, v7
  v_mov_b32 v60, 0
  v_mov_b32 v61, 0
  v_mov_b32 v62, 0
  v_mov_b32 v63, 0
  v_mov_b32 v64, 0
  v_mov_b32 v65, 0
  v_mov_b32 v66, 0
  v_mov_b32 v67, 0
  v_mov_b32 v68, 0
  v_mov_b32 v69, 0
  v_mov_b32 v70, 0
  v_mov_b32 v71, 0
  v_mov_b32 v72, 0
  v_mov_b32 v73, 0
  v_mov_b32 v74, 0
  v_mov_b32 v75, 0
  v_mov_b32 v84, 0x3f803f80
  v_mov_b32 v85, 0x3f803f80
  v_mov_b32 v86, 0x3f803f80
  v_mov_b32 v87, 0x3f803f80
  v_mov_b32 v88, 0x3f803f80
  v_mov_b32 v89, 0x3f803f80
  v_mov_b32 v90, 0x3f803f80
  v_mov_b32 v91, 0x3f803f80
  v_lshrrev_b32 v7, 5, v1
  v_lshlrev_b32 v7, 8, v7
  v_and_b32 v4, 15, v1
  v_lshl_add_u32 v4, v4, 4, v7
  s_add_u32 s56, s53, 2097152
  s_add_u32 s57, s53, 4194304
  s_mov_b32 s61, 0
  s_mov_b32 s62, 0x0000ffff
  s_mov_b32 s63, 0x0000ffff
ATT_S2:
  buffer_load_dwordx4 v[76:79], v2, s[32:35], s56 offen sc1
  s_mov_b64 exec, s[62:63]
  buffer_load_dwordx4 v[84:87], v4, s[32:35], s57 offen sc1
  buffer_load_dwordx4 v[88:91], v4, s[32:35], s57 offen offset:512 sc1
  s_mov_b64 exec, -1
  s_add_u32 s56, s56, 1024
  s_add_u32 s57, s57, 1024
  s_waitcnt vmcnt(0)
  v_mfma_f32_32x32x16_bf16 v[28:43], v[76:79], v[8:11], v[12:27]
  s_nop 11
  v_exp_f32 v28, v28
  v_exp_f32 v29, v29
  v_exp_f32 v30, v30
  v_exp_f32 v31, v31
  v_exp_f32 v32, v32
  v_exp_f32 v33, v33
  v_exp_f32 v34, v34
  v_exp_f32 v35, v35
  v_exp_f32 v36, v36
  v_exp_f32 v37, v37
  v_exp_f32 v38, v38
  v_exp_f32 v39, v39
  v_exp_f32 v40, v40
  v_exp_f32 v41, v41
  v_exp_f32 v42, v42
  v_exp_f32 v43, v43
  v_cvt_pk_bf16_f32 v44, v28, v29
  v_cvt_pk_bf16_f32 v45, v30, v31
  v_cvt_pk_bf16_f32 v46, v32, v33
  v_cvt_pk_bf16_f32 v47, v34, v35
  v_cvt_pk_bf16_f32 v48, v36, v37
  v_cvt_pk_bf16_f32 v49, v38, v39
  v_cvt_pk_bf16_f32 v50, v40, v41
  v_cvt_pk_bf16_f32 v51, v42, v43
  v_mfma_f32_32x32x16_bf16 v[60:75], v[84:87], v[44:47], v[60:75]
  s_nop 0
  v_mfma_f32_32x32x16_bf16 v[60:75], v[88:91], v[48:51], v[60:75]
  s_add_u32 s61, s61, 1
  s_cmp_lt_u32 s61, 64
  s_cbranch_scc1 ATT_S2
  s_branch ATT_FIN
ROLE_B:
  s_sub_u32 s2, s2, 256
  s_setprio 3
  s_and_b32 s53, s2, 7
  s_lshr_b32 s54, s2, 3
  v_lshlrev_b32 v2, 4, v1
  s_cmp_lg_u32 s30, 7
  s_cbranch_scc1 B_NOCPF
  s_getpc_b64 s[56:57]
B_PCREF:
  s_sub_u32 s56, s56, B_PCREF-K_START
  s_subb_u32 s57, s57, 0
  s_lshl_b32 s55, s54, 3
  v_add_u32 v8, s55, v1
  v_lshlrev_b32 v8, 7, v8
  v_min_u32 v8, K_END-K_START, v8
  s_mov_b64 exec, 0xff
  global_load_dword v15, v8, s[56:57]
  s_mov_b64 exec, -1
B_NOCPF:
  s_and_b32 s55, s53, 3
  s_lshl_b32 s55, s55, 6
  s_lshr_b32 s56, s53, 2
  s_lshl_b32 s56, s56, 5
  s_add_u32 s55, s55, s56
  s_add_u32 s55, s55, s54
  s_lshl_b32 s55, s54, 3
  s_add_u32 s55, s55, s53
  s_and_b32 s56, s55, 1
  s_lshr_b32 s55, s55, 1
  s_lshl_b32 s55, s55, 4
  s_lshl_b32 s57, s56, 2
  s_add_u32 s57, s57, s55
  s_and_b32 s58, s30, 3
  s_add_u32 s57, s57, s58
  s_lshr_b32 s58, s30, 2
  s_lshl_b32 s58, s58, 3
  s_add_u32 s57, s57, s58
  s_lshl_b32 s58, s57, 10
  s_waitcnt lgkmcnt(0)
  s_mov_b32 s36, s4
  s_mov_b32 s37, s5
  s_mov_b32 s38, 2097152
  s_mov_b32 s39, 0x00020000
  s_mov_b32 s40, s20
  s_mov_b32 s41, s21
  s_mov_b32 s42, 1024
  s_mov_b32 s43, 0x00020000
  buffer_load_dwordx4 v[16:19], v2, s[36:39], s58 offen
  buffer_load_dwordx4 v[20:23], v2, s[40:43], 0 offen
  s_mov_b32 s32, s26
  s_mov_b32 s33, s27
  s_mov_b32 s34, 16777216
  s_mov_b32 s35, 0x00020000
  s_add_u32 s64, s26, 12615680
  s_addc_u32 s65, s27, 0
  s_load_dwordx2 s[66:67], s[64:65], 0
  s_waitcnt vmcnt(0)
  v_lshlrev_b32 v32, 16, v16
  v_and_b32 v33, 0xffff0000, v16
  v_lshlrev_b32 v34, 16, v17
  v_and_b32 v35, 0xffff0000, v17
  v_lshlrev_b32 v36, 16, v18
  v_and_b32 v37, 0xffff0000, v18
  v_lshlrev_b32 v38, 16, v19
  v_and_b32 v39, 0xffff0000, v19
  v_lshlrev_b32 v40, 16, v20
  v_and_b32 v41, 0xffff0000, v20
  v_lshlrev_b32 v42, 16, v21
  v_and_b32 v43, 0xffff0000, v21
  v_lshlrev_b32 v44, 16, v22
  v_and_b32 v45, 0xffff0000, v22
  v_lshlrev_b32 v46, 16, v23
  v_and_b32 v47, 0xffff0000, v23
  v_add_f32 v48, v32, v33
  v_mul_f32 v49, v32, v40
  v_add_f32 v48, v48, v34
  v_add_f32 v48, v48, v35
  v_add_f32 v48, v48, v36
  v_add_f32 v48, v48, v37
  v_add_f32 v48, v48, v38
  v_add_f32 v48, v48, v39
  v_fmac_f32 v49, v33, v41
  v_fmac_f32 v49, v34, v42
  v_fmac_f32 v49, v35, v43
  v_fmac_f32 v49, v36, v44
  v_fmac_f32 v49, v37, v45
  v_fmac_f32 v49, v38, v46
  v_fmac_f32 v49, v39, v47
  v_add_f32_dpp v48, v48, v48 row_shr:1 row_mask:0xf bank_mask:0xf bound_ctrl:0
  s_nop 0
  v_add_f32_dpp v49, v49, v49 row_shr:1 row_mask:0xf bank_mask:0xf bound_ctrl:0
  v_add_f32_dpp v48, v48, v48 row_shr:2 row_mask:0xf bank_mask:0xf bound_ctrl:0
  s_nop 0
  v_add_f32_dpp v49, v49, v49 row_shr:2 row_mask:0xf bank_mask:0xf bound_ctrl:0
  v_add_f32_dpp v48, v48, v48 row_shr:4 row_mask:0xf bank_mask:0xf bound_ctrl:0
  s_nop 0
  v_add_f32_dpp v49, v49, v49 row_shr:4 row_mask:0xf bank_mask:0xf bound_ctrl:0
  v_add_f32_dpp v48, v48, v48 row_shr:8 row_mask:0xf bank_mask:0xf bound_ctrl:0
  s_nop 0
  v_add_f32_dpp v49, v49, v49 row_shr:8 row_mask:0xf bank_mask:0xf bound_ctrl:0
  v_add_f32_dpp v48, v48, v48 row_bcast:15 row_mask:0xa bank_mask:0xf
  s_nop 0
  v_add_f32_dpp v49, v49, v49 row_bcast:15 row_mask:0xa bank_mask:0xf
  v_add_f32_dpp v48, v48, v48 row_bcast:31 row_mask:0xc bank_mask:0xf
  s_nop 0
  v_add_f32_dpp v49, v49, v49 row_bcast:31 row_mask:0xc bank_mask:0xf
  v_readlane_b32 s59, v48, 63
  v_readlane_b32 s60, v49, 63
  v_mov_b32 v50, 0xbb000000
  v_mul_f32 v51, s59, v50
  v_add_f32 v32, v32, v51
  v_add_f32 v33, v33, v51
  v_add_f32 v34, v34, v51
  v_add_f32 v35, v35, v51
  v_add_f32 v36, v36, v51
  v_add_f32 v37, v37, v51
  v_add_f32 v38, v38, v51
  v_add_f32 v39, v39, v51
  v_mul_f32 v48, v32, v32
  v_fmac_f32 v48, v33, v33
  v_fmac_f32 v48, v34, v34
  v_fmac_f32 v48, v35, v35
  v_fmac_f32 v48, v36, v36
  v_fmac_f32 v48, v37, v37
  v_fmac_f32 v48, v38, v38
  v_fmac_f32 v48, v39, v39
  v_mov_b32 v52, 0xbfb8aa3b
  v_mul_f32 v52, s60, v52
  v_exp_f32 v52, v52
  v_add_f32_dpp v48, v48, v48 row_shr:1 row_mask:0xf bank_mask:0xf bound_ctrl:0
  s_nop 1
  v_add_f32_dpp v48, v48, v48 row_shr:2 row_mask:0xf bank_mask:0xf bound_ctrl:0
  s_nop 1
  v_add_f32_dpp v48, v48, v48 row_shr:4 row_mask:0xf bank_mask:0xf bound_ctrl:0
  s_nop 1
  v_add_f32_dpp v48, v48, v48 row_shr:8 row_mask:0xf bank_mask:0xf bound_ctrl:0
  s_nop 1
  v_add_f32_dpp v48, v48, v48 row_bcast:15 row_mask:0xa bank_mask:0xf
  s_nop 1
  v_add_f32_dpp v48, v48, v48 row_bcast:31 row_mask:0xc bank_mask:0xf
  v_add_f32 v52, 1.0, v52
  v_rcp_f32 v52, v52
  v_readlane_b32 s59, v48, 63
  v_mov_b32 v50, 0x3b000000
  v_mov_b32 v53, 0x3727c5ac
  v_fma_f32 v51, s59, v50, v53
  v_rsq_f32 v51, v51
  s_lshl_b32 s59, s57, 2
  s_add_u32 s59, s59, 12582912
  v_mov_b32 v53, 0
  v_mul_f32 v32, v32, v51
  v_mul_f32 v33, v33, v51
  v_mul_f32 v34, v34, v51
  v_mul_f32 v35, v35, v51
  v_mul_f32 v36, v36, v51
  v_mul_f32 v37, v37, v51
  v_mul_f32 v38, v38, v51
  v_mul_f32 v39, v39, v51
  v_cvt_pk_bf16_f32 v16, v32, v33
  v_cvt_pk_bf16_f32 v17, v34, v35
  v_cvt_pk_bf16_f32 v18, v36, v37
  v_cvt_pk_bf16_f32 v19, v38, v39
  s_lshl_b32 s60, s30, 10
  s_add_u32 s60, s60, 32768
  v_add_u32 v8, s60, v2
  ds_write_b128 v8, v[16:19]
  s_mov_b64 exec, 1
  buffer_store_dword v52, v53, s[32:35], s59 offen sc1
  s_mov_b64 exec, -1
  v_bfe_u32 v8, v1, 2, 2
  v_lshlrev_b32 v8, 10, v8
  v_lshrrev_b32 v9, 4, v1
  v_lshl_add_u32 v8, v9, 5, v8
  v_and_b32 v9, 3, v1
  v_lshl_add_u32 v8, v9, 3, v8
  s_lshl_b32 s60, s30, 7
  s_add_u32 s60, s60, 32768
  v_add_u32 v8, s60, v8
  s_lshl_b32 s59, s55, 7
  s_lshl_b32 s60, s56, 9
  s_add_u32 s59, s59, s60
  s_lshl_b32 s60, s30, 18
  s_add_u32 s59, s59, s60
  s_add_u32 s59, s59, 6291456
  v_lshrrev_b32 v9, 5, v1
  v_lshlrev_b32 v9, 10, v9
  v_and_b32 v50, 31, v1
  v_lshl_add_u32 v9, v50, 4, v9
  s_waitcnt lgkmcnt(0)
  s_add_u32 s28, s66, 1
  s_addc_u32 s29, s67, 0
  s_barrier
  ds_read_b64_tr_b16 v[16:17], v8
  ds_read_b64_tr_b16 v[18:19], v8 offset:4096
  s_lshl_b32 s60, s2, 3
  s_add_u32 s60, s60, 12681216
  s_waitcnt lgkmcnt(0)
  buffer_store_dwordx4 v[16:19], v9, s[32:35], s59 offen sc1
  s_waitcnt vmcnt(0)
  s_barrier
  s_cmp_lg_u32 s30, 0
  s_cbranch_scc1 PF_h
  v_mov_b32 v16, s28
  v_mov_b32 v17, s29
  v_mov_b32 v18, 0
  s_mov_b64 exec, 1
  buffer_store_dwordx2 v[16:17], v18, s[32:35], s60 offen sc1
  s_mov_b64 exec, -1
PF_h:
  s_cmp_lt_u32 s30, 4
  s_cbranch_scc1 B_MAIN
  s_endpgm
B_MAIN:
  s_lshl_b32 s48, s30, 13
  s_lshr_b32 s65, s30, 1
  s_and_b32 s66, s30, 1
  s_lshl_b32 s67, s53, 2
  s_and_b32 s68, s54, 3
  s_add_u32 s67, s67, s68
  s_lshr_b32 s68, s54, 2
  s_and_b32 s58, s54, 3
  s_lshl_b32 s58, s58, 1
  s_add_u32 s58, s58, s68
  s_sub_u32 s59, s58, 7
  s_cmp_ge_u32 s58, 7
  s_cselect_b32 s69, s59, s58
  s_lshl_b32 s69, s69, 2
  s_lshl_b32 s57, s67, 7
  v_lshrrev_b32 v8, 3, v1
  s_lshl_b32 s52, s30, 4
  v_add_u32 v8, s52, v8
  v_mul_u32_u24 v13, 4096, v8
  v_bfe_u32 v8, v1, 4, 1
  v_lshlrev_b32 v8, 2, v8
  v_and_b32 v9, 7, v1
  v_xor_b32 v8, v8, v9
  v_lshl_add_u32 v13, v8, 4, v13
  v_add_u32 v13, s57, v13
  v_add_u32 v14, 32768, v13
  s_cmp_ge_u32 s2, 224
  s_cbranch_scc1 B_G2_ENTRY
  s_and_b32 s55, s53, 1
  s_lshl_b32 s55, s55, 2
  s_and_b32 s56, s54, 3
  s_add_u32 s55, s55, s56
  s_lshr_b32 s56, s53, 1
  s_mul_i32 s56, s56, 7
  s_lshr_b32 s57, s54, 2
  s_add_u32 s56, s56, s57
  s_lshl_b32 s57, s56, 7
  s_mov_b32 s36, s12
  s_mov_b32 s37, s13
  s_mov_b32 s38, 7340032
  s_mov_b32 s39, 0x00020000
  s_mov_b32 s40, s14
  s_mov_b32 s41, s15
  s_mov_b32 s42, 3584
  s_mov_b32 s43, 0x00020000
  s_lshl_b32 s59, s65, 6
  s_add_u32 s59, s59, s57
  v_lshrrev_b32 v9, 5, v1
  v_lshlrev_b32 v9, 3, v9
  buffer_load_dwordx2 v[80:81], v9, s[40:43], s59 offen offset:0
  buffer_load_dwordx2 v[82:83], v9, s[40:43], s59 offen offset:16
  buffer_load_dwordx2 v[84:85], v9, s[40:43], s59 offen offset:32
  buffer_load_dwordx2 v[86:87], v9, s[40:43], s59 offen offset:48
  s_and_b32 s58, s54, 3
  s_lshl_b32 s58, s58, 1
  s_lshr_b32 s59, s54, 2
  s_add_u32 s58, s58, s59
  s_and_b32 s58, s58, 7
  s_and_b32 s58, s54, 3
  s_add_u32 s58, s58, s59
  s_and_b32 s63, s58, 3
  v_lshrrev_b32 v8, 3, v1
  s_lshl_b32 s52, s30, 4
  v_add_u32 v8, s52, v8
  v_mul_u32_u24 v3, 3584, v8
  v_bfe_u32 v8, v1, 4, 1
  v_lshlrev_b32 v8, 2, v8
  v_and_b32 v9, 7, v1
  v_xor_b32 v8, v8, v9
  v_lshl_add_u32 v3, v8, 4, v3
  v_add_u32 v3, s57, v3
  v_add_u32 v4, 28672, v3
  v_lshrrev_b32 v8, 5, v1
  v_lshlrev_b32 v6, 9, v8
  v_bfe_u32 v8, v1, 2, 2
  v_lshl_add_u32 v6, v8, 7, v6
  v_lshrrev_b32 v8, 1, v8
  v_xor_b32 v8, s65, v8
  v_lshl_add_u32 v6, v8, 6, v6
  v_bfe_u32 v8, v1, 4, 1
  v_lshl_add_u32 v6, v8, 5, v6
  v_and_b32 v8, 3, v1
  v_lshl_add_u32 v6, v8, 3, v6
  v_add_u32 v6, s48, v6
  v_xor_b32 v7, 64, v6
  s_lshl_b32 s52, s30, 1
  s_add_u32 s52, s52, s66
  s_lshl_b32 s52, s52, 10
  v_add_u32 v5, s52, v2
  v_xor_b32 v10, 1024, v5
  s_lshl_b32 s62, s55, 18
  s_add_u32 s62, s62, 6291456
  s_mov_b32 s40, s16
  s_mov_b32 s41, s17
  s_mov_b32 s42, 7340032
  s_mov_b32 s43, 0x00020000
  s_waitcnt vmcnt(0)
  v_lshlrev_b32 v64, 16, v80
  v_and_b32 v65, 0xffff0000, v80
  v_lshlrev_b32 v66, 16, v81
  v_and_b32 v67, 0xffff0000, v81
  v_lshlrev_b32 v68, 16, v82
  v_and_b32 v69, 0xffff0000, v82
  v_lshlrev_b32 v70, 16, v83
  v_and_b32 v71, 0xffff0000, v83
  v_lshlrev_b32 v72, 16, v84
  v_and_b32 v73, 0xffff0000, v84
  v_lshlrev_b32 v74, 16, v85
  v_and_b32 v75, 0xffff0000, v85
  v_lshlrev_b32 v76, 16, v86
  v_and_b32 v77, 0xffff0000, v86
  v_lshlrev_b32 v78, 16, v87
  v_and_b32 v79, 0xffff0000, v87
  s_lshl_b32 s58, s2, 7
  s_add_u32 s58, s58, 12779520
  v_mov_b32 v8, 0
  s_cmp_lg_u32 s30, 0
  s_cbranch_scc1 PD_go
  s_mov_b32 s71, 20000
  s_mov_b32 exec_lo, 0x1
  s_mov_b32 exec_hi, 0
PL_go:
  buffer_load_dwordx2 v[16:17], v8, s[32:35], s58 offen sc1
  s_waitcnt vmcnt(0)
  v_cmp_ne_u64 vcc, s[28:29], v[16:17]
  s_cbranch_vccz PD_go
  s_mov_b64 exec, vcc
  s_sleep 2
  s_sub_u32 s71, s71, 1
  s_cmp_lg_u32 s71, 0
  s_cbranch_scc1 PL_go
PD_go:
  s_mov_b64 exec, -1
  s_barrier
  s_setprio 0
  s_lshl_b32 s60, s30, 9
  s_add_u32 s60, s60, 12681216
  v_lshlrev_b32 v9, 3, v1
  buffer_load_dwordx2 v[16:17], v9, s[32:35], s60 offen sc1
  s_add_u32 s52, 0, s63
  s_and_b32 s52, s52, 3
  s_andn2_b32 s70, 0, 3
  s_or_b32 s52, s52, s70
  s_mul_i32 s49, s52, 229376
  s_lshl_b32 s52, s52, 13
  s_add_u32 s50, s62, s52
  s_add_u32 m0, s48, 0
  s_nop 0
  buffer_load_dwordx4 v3, s[36:39], s49 offen lds
  s_add_u32 m0, s48, 1024
  s_nop 0
  buffer_load_dwordx4 v4, s[36:39], s49 offen lds
  s_add_u32 s52, 1, s63
  s_and_b32 s52, s52, 3
  s_andn2_b32 s70, 1, 3
  s_or_b32 s52, s52, s70
  s_mul_i32 s49, s52, 229376
  s_lshl_b32 s52, s52, 13
  s_add_u32 s50, s62, s52
  s_add_u32 m0, s48, 2048
  s_nop 0
  buffer_load_dwordx4 v3, s[36:39], s49 offen lds
  s_add_u32 m0, s48, 3072
  s_nop 0
  buffer_load_dwordx4 v4, s[36:39], s49 offen lds
  s_add_u32 s52, 2, s63
  s_and_b32 s52, s52, 3
  s_andn2_b32 s70, 2, 3
  s_or_b32 s52, s52, s70
  s_mul_i32 s49, s52, 229376
  s_lshl_b32 s52, s52, 13
  s_add_u32 s50, s62, s52
  s_add_u32 m0, s48, 4096
  s_nop 0
  buffer_load_dwordx4 v3, s[36:39], s49 offen lds
  s_add_u32 m0, s48, 5120
  s_nop 0
  buffer_load_dwordx4 v4, s[36:39], s49 offen lds
  s_add_u32 s52, 3, s63
  s_and_b32 s52, s52, 3
  s_andn2_b32 s70, 3, 3
  s_or_b32 s52, s52, s70
  s_mul_i32 s49, s52, 229376
  s_lshl_b32 s52, s52, 13
  s_add_u32 s50, s62, s52
  s_add_u32 m0, s48, 6144
  s_nop 0
  buffer_load_dwordx4 v3, s[36:39], s49 offen lds
  s_add_u32 m0, s48, 7168
  s_nop 0
  buffer_load_dwordx4 v4, s[36:39], s49 offen lds
  s_waitcnt vmcnt(8)
  v_cmp_ne_u64 vcc, s[28:29], v[16:17]
  s_cbranch_vccz B_HOK
  s_mov_b32 s71, 20000
PL_h:
  buffer_load_dwordx2 v[16:17], v9, s[32:35], s60 offen sc1
  s_waitcnt vmcnt(0)
  v_cmp_ne_u64 vcc, s[28:29], v[16:17]
  s_cbranch_vccz PD_h
  s_mov_b64 exec, vcc
  s_sleep 16
  s_sub_u32 s71, s71, 1
  s_cmp_lg_u32 s71, 0
  s_cbranch_scc1 PL_h
PD_h:
  s_mov_b64 exec, -1
B_HOK:
  s_barrier
  s_add_u32 s52, 0, s63
  s_and_b32 s52, s52, 3
  s_andn2_b32 s70, 0, 3
  s_or_b32 s52, s52, s70
  s_mul_i32 s49, s52, 229376
  s_lshl_b32 s52, s52, 13
  s_add_u32 s50, s62, s52
  buffer_load_dwordx4 v[32:35], v5, s[32:35], s50 offen sc1
  buffer_load_dwordx4 v[36:39], v10, s[32:35], s50 offen sc1
  s_add_u32 s52, 1, s63
  s_and_b32 s52, s52, 3
  s_andn2_b32 s70, 1, 3
  s_or_b32 s52, s52, s70
  s_mul_i32 s49, s52, 229376
  s_lshl_b32 s52, s52, 13
  s_add_u32 s50, s62, s52
  buffer_load_dwordx4 v[40:43], v5, s[32:35], s50 offen sc1
  buffer_load_dwordx4 v[44:47], v10, s[32:35], s50 offen sc1
  s_add_u32 s52, 2, s63
  s_and_b32 s52, s52, 3
  s_andn2_b32 s70, 2, 3
  s_or_b32 s52, s52, s70
  s_mul_i32 s49, s52, 229376
  s_lshl_b32 s52, s52, 13
  s_add_u32 s50, s62, s52
  buffer_load_dwordx4 v[48:51], v5, s[32:35], s50 offen sc1
  buffer_load_dwordx4 v[52:55], v10, s[32:35], s50 offen sc1
  s_add_u32 s52, 3, s63
  s_and_b32 s52, s52, 3
  s_andn2_b32 s70, 3, 3
  s_or_b32 s52, s52, s70
  s_mul_i32 s49, s52, 229376
  s_lshl_b32 s52, s52, 13
  s_add_u32 s50, s62, s52
  buffer_load_dwordx4 v[56:59], v5, s[32:35], s50 offen sc1
  buffer_load_dwordx4 v[60:63], v10, s[32:35], s50 offen sc1
  s_mov_b32 s51, 4
  s_add_u32 s52, s51, s63
  s_and_b32 s52, s52, 3
  s_andn2_b32 s70, s51, 3
  s_or_b32 s52, s52, s70
  s_mul_i32 s49, s52, 229376
  s_lshl_b32 s52, s52, 13
  s_add_u32 s50, s62, s52
  s_waitcnt vmcnt(8)
  ds_read_b64_tr_b16 v[16:17], v6 offset:0
  ds_read_b64_tr_b16 v[18:19], v6 offset:1024
  ds_read_b64_tr_b16 v[20:21], v7 offset:0
  ds_read_b64_tr_b16 v[22:23], v7 offset:1024
  s_waitcnt vmcnt(0)
  ds_read_b64_tr_b16 v[24:25], v6 offset:2048
  ds_read_b64_tr_b16 v[26:27], v6 offset:3072
  ds_read_b64_tr_b16 v[28:29], v7 offset:2048
  ds_read_b64_tr_b16 v[30:31], v7 offset:3072
  s_waitcnt lgkmcnt(4)
  s_add_u32 m0, s48, 0
  v_mfma_f32_32x32x16_bf16 v[64:79], v[16:19], v[32:35], v[64:79]
  buffer_load_dwordx4 v3, s[36:39], s49 offen lds
  s_add_u32 m0, s48, 1024
  v_mfma_f32_32x32x16_bf16 v[96:111], v[20:23], v[32:35], 0
  buffer_load_dwordx4 v[32:35], v5, s[32:35], s50 offen sc1
  v_mfma_f32_32x32x16_bf16 v[80:95], v[16:19], v[36:39], 0
  buffer_load_dwordx4 v4, s[36:39], s49 offen lds
  v_mfma_f32_32x32x16_bf16 v[112:127], v[20:23], v[36:39], 0
  buffer_load_dwordx4 v[36:39], v10, s[32:35], s50 offen sc1
  s_add_u32 s51, s51, 1
  s_add_u32 s52, s51, s63
  s_and_b32 s52, s52, 3
  s_andn2_b32 s70, s51, 3
  s_or_b32 s52, s52, s70
  s_mul_i32 s49, s52, 229376
  s_lshl_b32 s52, s52, 13
  s_add_u32 s50, s62, s52
  s_branch GM_g1
GL_g1:
  s_waitcnt vmcnt(8)
  ds_read_b64_tr_b16 v[24:25], v6 offset:2048
  ds_read_b64_tr_b16 v[26:27], v6 offset:3072
  ds_read_b64_tr_b16 v[28:29], v7 offset:2048
  ds_read_b64_tr_b16 v[30:31], v7 offset:3072
  s_waitcnt lgkmcnt(4)
  s_add_u32 m0, s48, 0
  v_mfma_f32_32x32x16_bf16 v[64:79], v[16:19], v[32:35], v[64:79]
  buffer_load_dwordx4 v3, s[36:39], s49 offen lds
  s_add_u32 m0, s48, 1024
  v_mfma_f32_32x32x16_bf16 v[96:111], v[20:23], v[32:35], v[96:111]
  buffer_load_dwordx4 v[32:35], v5, s[32:35], s50 offen sc1
  v_mfma_f32_32x32x16_bf16 v[80:95], v[16:19], v[36:39], v[80:95]
  buffer_load_dwordx4 v4, s[36:39], s49 offen lds
  v_mfma_f32_32x32x16_bf16 v[112:127], v[20:23], v[36:39], v[112:127]
  buffer_load_dwordx4 v[36:39], v10, s[32:35], s50 offen sc1
  s_add_u32 s51, s51, 1
  s_add_u32 s52, s51, s63
  s_and_b32 s52, s52, 3
  s_andn2_b32 s70, s51, 3
  s_or_b32 s52, s52, s70
  s_mul_i32 s49, s52, 229376
  s_lshl_b32 s52, s52, 13
  s_add_u32 s50, s62, s52
GM_g1:
  s_waitcnt vmcnt(8)
  ds_read_b64_tr_b16 v[16:17], v6 offset:4096
  ds_read_b64_tr_b16 v[18:19], v6 offset:5120
  ds_read_b64_tr_b16 v[20:21], v7 offset:4096
  ds_read_b64_tr_b16 v[22:23], v7 offset:5120
  s_waitcnt lgkmcnt(4)
  s_add_u32 m0, s48, 2048
  v_mfma_f32_32x32x16_bf16 v[64:79], v[24:27], v[40:43], v[64:79]
  buffer_load_dwordx4 v3, s[36:39], s49 offen lds
  s_add_u32 m0, s48, 3072
  v_mfma_f32_32x32x16_bf16 v[96:111], v[28:31], v[40:43], v[96:111]
  buffer_load_dwordx4 v[40:43], v5, s[32:35], s50 offen sc1
  v_mfma_f32_32x32x16_bf16 v[80:95], v[24:27], v[44:47], v[80:95]
  buffer_load_dwordx4 v4, s[36:39], s49 offen lds
  v_mfma_f32_32x32x16_bf16 v[112:127], v[28:31], v[44:47], v[112:127]
  buffer_load_dwordx4 v[44:47], v10, s[32:35], s50 offen sc1
  s_add_u32 s51, s51, 1
  s_add_u32 s52, s51, s63
  s_and_b32 s52, s52, 3
  s_andn2_b32 s70, s51, 3
  s_or_b32 s52, s52, s70
  s_mul_i32 s49, s52, 229376
  s_lshl_b32 s52, s52, 13
  s_add_u32 s50, s62, s52
  s_waitcnt vmcnt(8)
  ds_read_b64_tr_b16 v[24:25], v6 offset:6144
  ds_read_b64_tr_b16 v[26:27], v6 offset:7168
  ds_read_b64_tr_b16 v[28:29], v7 offset:6144
  ds_read_b64_tr_b16 v[30:31], v7 offset:7168
  s_waitcnt lgkmcnt(4)
  s_add_u32 m0, s48, 4096
  v_mfma_f32_32x32x16_bf16 v[64:79], v[16:19], v[48:51], v[64:79]
  buffer_load_dwordx4 v3, s[36:39], s49 offen lds
  s_add_u32 m0, s48, 5120
  v_mfma_f32_32x32x16_bf16 v[96:111], v[20:23], v[48:51], v[96:111]
  buffer_load_dwordx4 v[48:51], v5, s[32:35], s50 offen sc1
  v_mfma_f32_32x32x16_bf16 v[80:95], v[16:19], v[52:55], v[80:95]
  buffer_load_dwordx4 v4, s[36:39], s49 offen lds
  v_mfma_f32_32x32x16_bf16 v[112:127], v[20:23], v[52:55], v[112:127]
  buffer_load_dwordx4 v[52:55], v10, s[32:35], s50 offen sc1
  s_add_u32 s51, s51, 1
  s_add_u32 s52, s51, s63
  s_and_b32 s52, s52, 3
  s_andn2_b32 s70, s51, 3
  s_or_b32 s52, s52, s70
  s_mul_i32 s49, s52, 229376
  s_lshl_b32 s52, s52, 13
  s_add_u32 s50, s62, s52
  s_waitcnt vmcnt(8)
  ds_read_b64_tr_b16 v[16:17], v6 offset:0
  ds_read_b64_tr_b16 v[18:19], v6 offset:1024
  ds_read_b64_tr_b16 v[20:21], v7 offset:0
  ds_read_b64_tr_b16 v[22:23], v7 offset:1024
  s_waitcnt lgkmcnt(4)
  s_add_u32 m0, s48, 6144
  v_mfma_f32_32x32x16_bf16 v[64:79], v[24:27], v[56:59], v[64:79]
  buffer_load_dwordx4 v3, s[36:39], s49 offen lds
  s_add_u32 m0, s48, 7168
  v_mfma_f32_32x32x16_bf16 v[96:111], v[28:31], v[56:59], v[96:111]
  buffer_load_dwordx4 v[56:59], v5, s[32:35], s50 offen sc1
  v_mfma_f32_32x32x16_bf16 v[80:95], v[24:27], v[60:63], v[80:95]
  buffer_load_dwordx4 v4, s[36:39], s49 offen lds
  v_mfma_f32_32x32x16_bf16 v[112:127], v[28:31], v[60:63], v[112:127]
  buffer_load_dwordx4 v[60:63], v10, s[32:35], s50 offen sc1
  s_add_u32 s51, s51, 1
  s_add_u32 s52, s51, s63
  s_and_b32 s52, s52, 3
  s_andn2_b32 s70, s51, 3
  s_or_b32 s52, s52, s70
  s_mul_i32 s49, s52, 229376
  s_lshl_b32 s52, s52, 13
  s_add_u32 s50, s62, s52
  s_cmp_lt_u32 s51, 32
  s_cbranch_scc1 GL_g1
  s_waitcnt vmcnt(8)
  ds_read_b64_tr_b16 v[24:25], v6 offset:2048
  ds_read_b64_tr_b16 v[26:27], v6 offset:3072
  ds_read_b64_tr_b16 v[28:29], v7 offset:2048
  ds_read_b64_tr_b16 v[30:31], v7 offset:3072
  s_waitcnt lgkmcnt(4)
  s_add_u32 s52, 0, s69
  s_sub_u32 s70, s52, 28
  s_cmp_ge_u32 s52, 28
  s_cselect_b32 s52, s70, s52
  s_mul_i32 s64, s52, 262144
  s_add_u32 m0, s48, 0
  v_mfma_f32_32x32x16_bf16 v[64:79], v[16:19], v[32:35], v[64:79]
  buffer_load_dwordx4 v13, s[40:43], s64 offen lds
  s_add_u32 m0, s48, 1024
  v_mfma_f32_32x32x16_bf16 v[96:111], v[20:23], v[32:35], v[96:111]
  v_mfma_f32_32x32x16_bf16 v[80:95], v[16:19], v[36:39], v[80:95]
  buffer_load_dwordx4 v14, s[40:43], s64 offen lds
  v_mfma_f32_32x32x16_bf16 v[112:127], v[20:23], v[36:39], v[112:127]
  s_waitcnt vmcnt(6)
  ds_read_b64_tr_b16 v[16:17], v6 offset:4096
  ds_read_b64_tr_b16 v[18:19], v6 offset:5120
  ds_read_b64_tr_b16 v[20:21], v7 offset:4096
  ds_read_b64_tr_b16 v[22:23], v7 offset:5120
  s_waitcnt lgkmcnt(4)
  s_add_u32 s52, 1, s69
  s_sub_u32 s70, s52, 28
  s_cmp_ge_u32 s52, 28
  s_cselect_b32 s52, s70, s52
  s_mul_i32 s64, s52, 262144
  s_add_u32 m0, s48, 2048
  v_mfma_f32_32x32x16_bf16 v[64:79], v[24:27], v[40:43], v[64:79]
  buffer_load_dwordx4 v13, s[40:43], s64 offen lds
  s_add_u32 m0, s48, 3072
  v_mfma_f32_32x32x16_bf16 v[96:111], v[28:31], v[40:43], v[96:111]
  v_mfma_f32_32x32x16_bf16 v[80:95], v[24:27], v[44:47], v[80:95]
  buffer_load_dwordx4 v14, s[40:43], s64 offen lds
  v_mfma_f32_32x32x16_bf16 v[112:127], v[28:31], v[44:47], v[112:127]
  s_waitcnt vmcnt(4)
  ds_read_b64_tr_b16 v[24:25], v6 offset:6144
  ds_read_b64_tr_b16 v[26:27], v6 offset:7168
  ds_read_b64_tr_b16 v[28:29], v7 offset:6144
  ds_read_b64_tr_b16 v[30:31], v7 offset:7168
  s_waitcnt lgkmcnt(4)
  s_add_u32 s52, 2, s69
  s_sub_u32 s70, s52, 28
  s_cmp_ge_u32 s52, 28
  s_cselect_b32 s52, s70, s52
  s_mul_i32 s64, s52, 262144
  s_add_u32 m0, s48, 4096
  v_mfma_f32_32x32x16_bf16 v[64:79], v[16:19], v[48:51], v[64:79]
  buffer_load_dwordx4 v13, s[40:43], s64 offen lds
  s_add_u32 m0, s48, 5120
  v_mfma_f32_32x32x16_bf16 v[96:111], v[20:23], v[48:51], v[96:111]
  v_mfma_f32_32x32x16_bf16 v[80:95], v[16:19], v[52:55], v[80:95]
  buffer_load_dwordx4 v14, s[40:43], s64 offen lds
  v_mfma_f32_32x32x16_bf16 v[112:127], v[20:23], v[52:55], v[112:127]
  s_waitcnt lgkmcnt(0)
  s_add_u32 s52, 3, s69
  s_sub_u32 s70, s52, 28
  s_cmp_ge_u32 s52, 28
  s_cselect_b32 s52, s70, s52
  s_mul_i32 s64, s52, 262144
  s_add_u32 m0, s48, 6144
  v_mfma_f32_32x32x16_bf16 v[64:79], v[24:27], v[56:59], v[64:79]
  buffer_load_dwordx4 v13, s[40:43], s64 offen lds
  s_add_u32 m0, s48, 7168
  v_mfma_f32_32x32x16_bf16 v[96:111], v[28:31], v[56:59], v[96:111]
  v_mfma_f32_32x32x16_bf16 v[80:95], v[24:27], v[60:63], v[80:95]
  buffer_load_dwordx4 v14, s[40:43], s64 offen lds
  v_mfma_f32_32x32x16_bf16 v[112:127], v[28:31], v[60:63], v[112:127]
  s_mov_b32 s44, s18
  s_mov_b32 s45, s19
  s_mov_b32 s46, 4096
  s_mov_b32 s47, 0x00020000
  v_and_b32 v8, 31, v1
  s_lshl_b32 s59, s66, 5
  v_add_u32 v8, s59, v8
  v_lshlrev_b32 v9, 2, v8
  v_lshlrev_b32 v8, 1, v8
  s_lshl_b32 s59, s67, 8
  s_add_u32 s59, s59, 12582912
  s_lshl_b32 s60, s67, 7
  buffer_load_dword v11, v9, s[32:35], s59 offen sc1
  buffer_load_ushort v12, v8, s[44:47], s60 offen
  s_setprio 3
  s_xor_b32 s52, s30, 3
  s_mul_i32 s52, s52, 12288
  s_add_u32 s52, s52, 40960
  v_add_u32 v19, s52, v2
  s_xor_b32 s52, s30, 2
  s_mul_i32 s52, s52, 12288
  s_add_u32 s52, s52, 36864
  v_add_u32 v18, s52, v2
  s_xor_b32 s52, s30, 1
  s_mul_i32 s52, s52, 12288
  s_add_u32 s52, s52, 32768
  v_add_u32 v17, s52, v2
  s_mul_i32 s52, s30, 12288
  s_add_u32 s52, s52, 32768
  v_add_u32 v8, s52, v2
  ds_write_b128 v18, v[96:99] offset:0
  ds_write_b128 v18, v[100:103] offset:1024
  ds_write_b128 v18, v[104:107] offset:2048
  ds_write_b128 v18, v[108:111] offset:3072
  ds_write_b128 v17, v[80:83] offset:0
  ds_write_b128 v17, v[84:87] offset:1024
  ds_write_b128 v17, v[88:91] offset:2048
  ds_write_b128 v17, v[92:95] offset:3072
  ds_write_b128 v19, v[112:115] offset:0
  ds_write_b128 v19, v[116:119] offset:1024
  ds_write_b128 v19, v[120:123] offset:2048
  ds_write_b128 v19, v[124:127] offset:3072
  s_waitcnt lgkmcnt(0)
  s_barrier
  ds_read_b128 v[80:83], v8 offset:0
  ds_read_b128 v[84:87], v8 offset:1024
  ds_read_b128 v[88:91], v8 offset:2048
  ds_read_b128 v[92:95], v8 offset:3072
  ds_read_b128 v[96:99], v8 offset:4096
  ds_read_b128 v[100:103], v8 offset:5120
  ds_read_b128 v[104:107], v8 offset:6144
  ds_read_b128 v[108:111], v8 offset:7168
  ds_read_b128 v[112:115], v8 offset:8192
  ds_read_b128 v[116:119], v8 offset:9216
  ds_read_b128 v[120:123], v8 offset:10240
  ds_read_b128 v[124:127], v8 offset:11264
  s_waitcnt lgkmcnt(8)
  v_pk_add_f32 v[64:65], v[64:65], v[80:81]
  v_pk_add_f32 v[66:67], v[66:67], v[82:83]
  v_pk_add_f32 v[68:69], v[68:69], v[84:85]
  v_pk_add_f32 v[70:71], v[70:71], v[86:87]
  v_pk_add_f32 v[72:73], v[72:73], v[88:89]
  v_pk_add_f32 v[74:75], v[74:75], v[90:91]
  v_pk_add_f32 v[76:77], v[76:77], v[92:93]
  v_pk_add_f32 v[78:79], v[78:79], v[94:95]
  s_waitcnt lgkmcnt(4)
  v_pk_add_f32 v[64:65], v[64:65], v[96:97]
  v_pk_add_f32 v[66:67], v[66:67], v[98:99]
  v_pk_add_f32 v[68:69], v[68:69], v[100:101]
  v_pk_add_f32 v[70:71], v[70:71], v[102:103]
  v_pk_add_f32 v[72:73], v[72:73], v[104:105]
  v_pk_add_f32 v[74:75], v[74:75], v[106:107]
  v_pk_add_f32 v[76:77], v[76:77], v[108:109]
  v_pk_add_f32 v[78:79], v[78:79], v[110:111]
  s_waitcnt lgkmcnt(0)
  v_pk_add_f32 v[64:65], v[64:65], v[112:113]
  v_pk_add_f32 v[66:67], v[66:67], v[114:115]
  v_pk_add_f32 v[68:69], v[68:69], v[116:117]
  v_pk_add_f32 v[70:71], v[70:71], v[118:119]
  v_pk_add_f32 v[72:73], v[72:73], v[120:121]
  v_pk_add_f32 v[74:75], v[74:75], v[122:123]
  v_pk_add_f32 v[76:77], v[76:77], v[124:125]
  v_pk_add_f32 v[78:79], v[78:79], v[126:127]
  v_mov_b32 v32, 0xc0135761
  v_mov_b32 v33, 0xc0135761
  v_mov_b32 v34, 0xbdd2d3e8
  v_mov_b32 v35, 0xbdd2d3e8
  v_mov_b32 v36, 0x3f800000
  v_mov_b32 v37, 0x3f800000
  v_pk_mul_f32 v[80:81], v[64:65], v[64:65]
  v_pk_mul_f32 v[82:83], v[66:67], v[66:67]
  v_pk_mul_f32 v[84:85], v[68:69], v[68:69]
  v_pk_mul_f32 v[86:87], v[70:71], v[70:71]
  v_pk_mul_f32 v[88:89], v[72:73], v[72:73]
  v_pk_mul_f32 v[90:91], v[74:75], v[74:75]
  v_pk_mul_f32 v[92:93], v[76:77], v[76:77]
  v_pk_mul_f32 v[94:95], v[78:79], v[78:79]
  v_pk_fma_f32 v[80:81], v[80:81], v[34:35], v[32:33]
  v_pk_fma_f32 v[82:83], v[82:83], v[34:35], v[32:33]
  v_pk_fma_f32 v[84:85], v[84:85], v[34:35], v[32:33]
  v_pk_fma_f32 v[86:87], v[86:87], v[34:35], v[32:33]
  v_pk_fma_f32 v[88:89], v[88:89], v[34:35], v[32:33]
  v_pk_fma_f32 v[90:91], v[90:91], v[34:35], v[32:33]
  v_pk_fma_f32 v[92:93], v[92:93], v[34:35], v[32:33]
  v_pk_fma_f32 v[94:95], v[94:95], v[34:35], v[32:33]
  v_pk_mul_f32 v[80:81], v[80:81], v[64:65]
  v_pk_mul_f32 v[82:83], v[82:83], v[66:67]
  v_pk_mul_f32 v[84:85], v[84:85], v[68:69]
  v_pk_mul_f32 v[86:87], v[86:87], v[70:71]
  v_pk_mul_f32 v[88:89], v[88:89], v[72:73]
  v_pk_mul_f32 v[90:91], v[90:91], v[74:75]
  v_pk_mul_f32 v[92:93], v[92:93], v[76:77]
  v_pk_mul_f32 v[94:95], v[94:95], v[78:79]
  v_exp_f32 v80, v80
  v_exp_f32 v81, v81
  v_exp_f32 v82, v82
  v_exp_f32 v83, v83
  v_exp_f32 v84, v84
  v_exp_f32 v85, v85
  v_exp_f32 v86, v86
  v_exp_f32 v87, v87
  v_exp_f32 v88, v88
  v_exp_f32 v89, v89
  v_exp_f32 v90, v90
  v_exp_f32 v91, v91
  v_exp_f32 v92, v92
  v_exp_f32 v93, v93
  v_exp_f32 v94, v94
  v_exp_f32 v95, v95
  v_pk_add_f32 v[80:81], v[80:81], v[36:37]
  v_pk_add_f32 v[82:83], v[82:83], v[36:37]
  v_pk_add_f32 v[84:85], v[84:85], v[36:37]
  v_pk_add_f32 v[86:87], v[86:87], v[36:37]
  v_pk_add_f32 v[88:89], v[88:89], v[36:37]
  v_pk_add_f32 v[90:91], v[90:91], v[36:37]
  v_pk_add_f32 v[92:93], v[92:93], v[36:37]
  v_pk_add_f32 v[94:95], v[94:95], v[36:37]
  v_rcp_f32 v80, v80
  v_rcp_f32 v81, v81
  v_rcp_f32 v82, v82
  v_rcp_f32 v83, v83
  v_rcp_f32 v84, v84
  v_rcp_f32 v85, v85
  v_rcp_f32 v86, v86
  v_rcp_f32 v87, v87
  v_rcp_f32 v88, v88
  v_rcp_f32 v89, v89
  v_rcp_f32 v90, v90
  v_rcp_f32 v91, v91
  v_rcp_f32 v92, v92
  v_rcp_f32 v93, v93
  v_rcp_f32 v94, v94
  v_rcp_f32 v95, v95
  s_mul_i32 s59, s55, 229376
  s_lshl_b32 s60, s56, 13
  s_add_u32 s59, s59, s60
  s_lshl_b32 s60, s65, 12
  s_add_u32 s59, s59, s60
  s_lshl_b32 s60, s66, 10
  s_add_u32 s59, s59, s60
  s_add_u32 s59, s59, 8388608
  v_pk_mul_f32 v[64:65], v[64:65], v[80:81]
  v_pk_mul_f32 v[66:67], v[66:67], v[82:83]
  v_pk_mul_f32 v[68:69], v[68:69], v[84:85]
  v_pk_mul_f32 v[70:71], v[70:71], v[86:87]
  v_pk_mul_f32 v[72:73], v[72:73], v[88:89]
  v_pk_mul_f32 v[74:75], v[74:75], v[90:91]
  v_pk_mul_f32 v[76:77], v[76:77], v[92:93]
  v_pk_mul_f32 v[78:79], v[78:79], v[94:95]
  v_cvt_pk_bf16_f32 v80, v64, v65
  v_cvt_pk_bf16_f32 v81, v66, v67
  v_cvt_pk_bf16_f32 v82, v68, v69
  v_cvt_pk_bf16_f32 v83, v70, v71
  v_cvt_pk_bf16_f32 v84, v72, v73
  v_cvt_pk_bf16_f32 v85, v74, v75
  v_cvt_pk_bf16_f32 v86, v76, v77
  v_cvt_pk_bf16_f32 v87, v78, v79
  buffer_store_dwordx4 v[80:83], v2, s[32:35], s59 offen sc1
  buffer_store_dwordx4 v[84:87], v2, s[32:35], s59 offen offset:2048 sc1
  s_lshl_b32 s60, s55, 5
  s_add_u32 s60, s60, s56
  s_lshl_b32 s60, s60, 7
  s_add_u32 s60, s60, 12713984
  s_waitcnt vmcnt(0)
  s_barrier
  s_cmp_lg_u32 s30, 0
  s_cbranch_scc1 PF_u
  v_mov_b32 v16, s28
  v_mov_b32 v17, s29
  v_mov_b32 v18, s28
  v_mov_b32 v19, s29
  v_lshlrev_b32 v20, 4, v1
  s_mov_b64 exec, 0xff
  buffer_store_dwordx4 v[16:19], v20, s[32:35], s60 offen sc1
  s_mov_b64 exec, -1
PF_u:
  s_branch B_G2
B_G2_ENTRY:
  s_mov_b32 s40, s16
  s_mov_b32 s41, s17
  s_mov_b32 s42, 7340032
  s_mov_b32 s43, 0x00020000
  s_mov_b32 s39, 0x00020000
  s_lshl_b32 s58, s2, 7
  s_add_u32 s58, s58, 12779520
  v_mov_b32 v8, 0
  s_cmp_lg_u32 s30, 0
  s_cbranch_scc1 PD_go2
  s_mov_b32 s71, 20000
  s_mov_b32 exec_lo, 0x1
  s_mov_b32 exec_hi, 0
PL_go2:
  buffer_load_dwordx2 v[16:17], v8, s[32:35], s58 offen sc1
  s_waitcnt vmcnt(0)
  v_cmp_ne_u64 vcc, s[28:29], v[16:17]
  s_cbranch_vccz PD_go2
  s_mov_b64 exec, vcc
  s_sleep 4
  s_sub_u32 s71, s71, 1
  s_cmp_lg_u32 s71, 0
  s_cbranch_scc1 PL_go2
PD_go2:
  s_mov_b64 exec, -1
  s_barrier
  s_lshl_b32 s60, s30, 9
  s_add_u32 s60, s60, 12681216
  v_lshlrev_b32 v9, 3, v1
  s_mov_b32 s71, 20000
PL_h2:
  buffer_load_dwordx2 v[16:17], v9, s[32:35], s60 offen sc1
  s_waitcnt vmcnt(0)
  v_cmp_ne_u64 vcc, s[28:29], v[16:17]
  s_cbranch_vccz PD_h2
  s_mov_b64 exec, vcc
  s_sleep 16
  s_sub_u32 s71, s71, 1
  s_cmp_lg_u32 s71, 0
  s_cbranch_scc1 PL_h2
PD_h2:
  s_mov_b64 exec, -1
  s_barrier
  s_mov_b32 s44, s18
  s_mov_b32 s45, s19
  s_mov_b32 s46, 4096
  s_mov_b32 s47, 0x00020000
  v_and_b32 v8, 31, v1
  s_lshl_b32 s59, s66, 5
  v_add_u32 v8, s59, v8
  v_lshlrev_b32 v9, 2, v8
  v_lshlrev_b32 v8, 1, v8
  s_lshl_b32 s59, s67, 8
  s_add_u32 s59, s59, 12582912
  s_lshl_b32 s60, s67, 7
  buffer_load_dword v11, v9, s[32:35], s59 offen sc1
  buffer_load_ushort v12, v8, s[44:47], s60 offen
  s_mov_b32 s44, s12
  s_mov_b32 s45, s13
  s_mov_b32 s46, 7340032
  s_mov_b32 s47, 0x00020000
  s_sub_u32 s58, s54, 28
  s_lshl_b32 s58, s58, 2
  s_add_u32 s58, s58, s30
  s_mov_b32 s59, 31
  s_cmp_ge_u32 s58, 11
  s_cselect_b32 s60, 11, 0
  s_cselect_b32 s59, 30, 31
  s_sub_u32 s58, s58, s60
  v_mul_u32_u24 v8, 3584, v1
  v_lshlrev_b32 v9, 7, v1
  s_lshr_b32 s55, s53, 1
  s_mul_i32 s55, s55, 896
  s_and_b32 s56, s53, 1
  s_lshl_b32 s56, s56, 20
  s_add_u32 s56, s56, 4456448
  s_mov_b32 s61, 6
IPF_L:
  s_cmp_ge_u32 s58, 7
  s_cbranch_scc1 IPF_H
  s_mul_i32 s60, s59, 229376
  s_add_u32 s60, s60, s55
  s_lshl_b32 s52, s58, 7
  s_add_u32 s60, s60, s52
  buffer_load_dword v15, v8, s[44:47], s60 offen
  s_branch IPF_N
IPF_H:
  s_lshl_b32 s60, s58, 18
  s_add_u32 s60, s60, s56
  s_lshl_b32 s52, s59, 13
  s_add_u32 s60, s60, s52
  buffer_load_dword v15, v9, s[32:35], s60 offen sc1
IPF_N:
  s_add_u32 s58, s58, 5
  s_sub_u32 s59, s59, 1
  s_cmp_ge_u32 s58, 11
  s_cselect_b32 s60, 11, 0
  s_cselect_b32 s52, 1, 0
  s_sub_u32 s58, s58, s60
  s_sub_u32 s59, s59, s52
  s_waitcnt vmcnt(0)
  s_sub_u32 s61, s61, 1
  s_cmp_lg_u32 s61, 0
  s_cbranch_scc1 IPF_L
  s_add_u32 s52, 0, s69
  s_sub_u32 s70, s52, 28
  s_cmp_ge_u32 s52, 28
  s_cselect_b32 s52, s70, s52
  s_mul_i32 s64, s52, 262144
  s_add_u32 m0, s48, 0
  s_nop 0
  buffer_load_dwordx4 v13, s[40:43], s64 offen lds
  s_add_u32 m0, s48, 1024
  s_nop 0
  buffer_load_dwordx4 v14, s[40:43], s64 offen lds
  s_add_u32 s52, 1, s69
  s_sub_u32 s70, s52, 28
  s_cmp_ge_u32 s52, 28
  s_cselect_b32 s52, s70, s52
  s_mul_i32 s64, s52, 262144
  s_add_u32 m0, s48, 2048
  s_nop 0
  buffer_load_dwordx4 v13, s[40:43], s64 offen lds
  s_add_u32 m0, s48, 3072
  s_nop 0
  buffer_load_dwordx4 v14, s[40:43], s64 offen lds
  s_add_u32 s52, 2, s69
  s_sub_u32 s70, s52, 28
  s_cmp_ge_u32 s52, 28
  s_cselect_b32 s52, s70, s52
  s_mul_i32 s64, s52, 262144
  s_add_u32 m0, s48, 4096
  s_nop 0
  buffer_load_dwordx4 v13, s[40:43], s64 offen lds
  s_add_u32 m0, s48, 5120
  s_nop 0
  buffer_load_dwordx4 v14, s[40:43], s64 offen lds
  s_add_u32 s52, 3, s69
  s_sub_u32 s70, s52, 28
  s_cmp_ge_u32 s52, 28
  s_cselect_b32 s52, s70, s52
  s_mul_i32 s64, s52, 262144
  s_add_u32 m0, s48, 6144
  s_nop 0
  buffer_load_dwordx4 v13, s[40:43], s64 offen lds
  s_add_u32 m0, s48, 7168
  s_nop 0
  buffer_load_dwordx4 v14, s[40:43], s64 offen lds
  s_waitcnt vmcnt(0)
B_G2:
  v_mov_b32 v3, v13
  v_mov_b32 v4, v14
  s_mov_b32 s36, s40
  s_mov_b32 s37, s41
  s_mov_b32 s38, s42
  s_mov_b32 s63, s69
  v_lshrrev_b32 v8, 5, v1
  v_lshlrev_b32 v6, 9, v8
  v_bfe_u32 v8, v1, 2, 2
  v_lshl_add_u32 v6, v8, 7, v6
  v_lshrrev_b32 v8, 1, v8
  v_xor_b32 v8, s66, v8
  v_lshl_add_u32 v6, v8, 6, v6
  v_bfe_u32 v8, v1, 4, 1
  v_lshl_add_u32 v6, v8, 5, v6
  v_and_b32 v8, 3, v1
  v_lshl_add_u32 v6, v8, 3, v6
  v_add_u32 v6, s48, v6
  v_xor_b32 v7, 64, v6
  s_lshl_b32 s52, s30, 1
  s_add_u32 s52, s52, s65
  s_lshl_b32 s52, s52, 10
  v_add_u32 v5, s52, v2
  v_xor_b32 v10, 1024, v5
  s_mul_i32 s62, s68, 229376
  s_add_u32 s62, s62, 8388608
  v_lshlrev_b32 v12, 16, v12
  v_mov_b32 v64, v12
  v_mov_b32 v65, v12
  v_mov_b32 v66, v12
  v_mov_b32 v67, v12
  v_mov_b32 v68, v12
  v_mov_b32 v69, v12
  v_mov_b32 v70, v12
  v_mov_b32 v71, v12
  v_mov_b32 v72, v12
  v_mov_b32 v73, v12
  v_mov_b32 v74, v12
  v_mov_b32 v75, v12
  v_mov_b32 v76, v12
  v_mov_b32 v77, v12
  v_mov_b32 v78, v12
  v_mov_b32 v79, v12
  s_mov_b32 s40, s8
  s_mov_b32 s41, s9
  s_mov_b32 s42, 524288
  s_mov_b32 s43, 0x00020000
  s_mov_b32 s44, s22
  s_mov_b32 s45, s23
  s_mov_b32 s46, 2097152
  s_mov_b32 s47, 0x00020000
  s_lshl_b32 s57, s68, 7
  v_lshrrev_b32 v8, 3, v1
  v_mul_u32_u24 v13, 1024, v8
  v_bfe_u32 v8, v1, 4, 1
  v_lshlrev_b32 v8, 2, v8
  v_and_b32 v9, 7, v1
  v_xor_b32 v8, v8, v9
  v_lshl_add_u32 v13, v8, 4, v13
  v_add_u32 v13, s57, v13
  v_add_u32 v14, 8192, v13
  s_mul_i32 s55, s30, 12288
  s_add_u32 s55, s55, 32768
  s_mul_i32 s64, s30, 6
  s_lshl_b32 s56, s65, 2
  s_add_u32 s64, s64, s56
  s_lshl_b32 s64, s64, 14
  s_lshl_b32 s56, s67, 1
  s_add_u32 s56, s56, s66
  s_lshl_b32 s56, s56, 1
  s_add_u32 s56, s56, s65
  s_lshl_b32 s56, s56, 11
  s_add_u32 s56, s56, 12845056
  v_lshlrev_b32 v8, 7, v1
  s_lshl_b32 s59, s68, 12
  s_add_u32 s59, s59, 12713984
  s_cmp_lg_u32 s30, 0
  s_cbranch_scc1 PD_u
  s_mov_b32 s71, 20000
  s_mov_b32 exec_lo, 0xfffffff
  s_mov_b32 exec_hi, 0
PL_u:
  buffer_load_dwordx2 v[16:17], v8, s[32:35], s59 offen sc1
  s_waitcnt vmcnt(0)
  v_cmp_ne_u64 vcc, s[28:29], v[16:17]
  s_cbranch_vccz PD_u
  s_mov_b64 exec, vcc
  s_sleep 2
  s_sub_u32 s71, s71, 1
  s_cmp_lg_u32 s71, 0
  s_cbranch_scc1 PL_u
PD_u:
  s_mov_b64 exec, -1
  s_barrier
  s_setprio 0
  s_add_u32 s52, 0, s63
  s_sub_u32 s70, s52, 28
  s_cmp_ge_u32 s52, 28
  s_cselect_b32 s52, s70, s52
  s_mul_i32 s49, s52, 262144
  s_lshl_b32 s52, s52, 13
  s_add_u32 s50, s62, s52
  buffer_load_dwordx4 v[32:35], v5, s[32:35], s50 offen sc1
  buffer_load_dwordx4 v[36:39], v10, s[32:35], s50 offen sc1
  s_add_u32 s52, 1, s63
  s_sub_u32 s70, s52, 28
  s_cmp_ge_u32 s52, 28
  s_cselect_b32 s52, s70, s52
  s_mul_i32 s49, s52, 262144
  s_lshl_b32 s52, s52, 13
  s_add_u32 s50, s62, s52
  buffer_load_dwordx4 v[40:43], v5, s[32:35], s50 offen sc1
  buffer_load_dwordx4 v[44:47], v10, s[32:35], s50 offen sc1
  s_add_u32 s52, 2, s63
  s_sub_u32 s70, s52, 28
  s_cmp_ge_u32 s52, 28
  s_cselect_b32 s52, s70, s52
  s_mul_i32 s49, s52, 262144
  s_lshl_b32 s52, s52, 13
  s_add_u32 s50, s62, s52
  buffer_load_dwordx4 v[48:51], v5, s[32:35], s50 offen sc1
  buffer_load_dwordx4 v[52:55], v10, s[32:35], s50 offen sc1
  s_add_u32 s52, 3, s63
  s_sub_u32 s70, s52, 28
  s_cmp_ge_u32 s52, 28
  s_cselect_b32 s52, s70, s52
  s_mul_i32 s49, s52, 262144
  s_lshl_b32 s52, s52, 13
  s_add_u32 s50, s62, s52
  buffer_load_dwordx4 v[56:59], v5, s[32:35], s50 offen sc1
  buffer_load_dwordx4 v[60:63], v10, s[32:35], s50 offen sc1
  s_mov_b32 s51, 4
  s_add_u32 s52, s51, s63
  s_sub_u32 s70, s52, 28
  s_cmp_ge_u32 s52, 28
  s_cselect_b32 s52, s70, s52
  s_mul_i32 s49, s52, 262144
  s_lshl_b32 s52, s52, 13
  s_add_u32 s50, s62, s52
  s_waitcnt vmcnt(8)
  ds_read_b64_tr_b16 v[16:17], v6 offset:0
  ds_read_b64_tr_b16 v[18:19], v6 offset:1024
  ds_read_b64_tr_b16 v[20:21], v7 offset:0
  ds_read_b64_tr_b16 v[22:23], v7 offset:1024
  s_waitcnt vmcnt(0)
  ds_read_b64_tr_b16 v[24:25], v6 offset:2048
  ds_read_b64_tr_b16 v[26:27], v6 offset:3072
  ds_read_b64_tr_b16 v[28:29], v7 offset:2048
  ds_read_b64_tr_b16 v[30:31], v7 offset:3072
  s_waitcnt lgkmcnt(4)
  s_add_u32 m0, s48, 0
  v_mfma_f32_32x32x16_bf16 v[64:79], v[32:35], v[16:19], v[64:79]
  buffer_load_dwordx4 v3, s[36:39], s49 offen lds
  s_add_u32 m0, s48, 1024
  v_mfma_f32_32x32x16_bf16 v[80:95], v[32:35], v[20:23], 0
  buffer_load_dwordx4 v[32:35], v5, s[32:35], s50 offen sc1
  v_mfma_f32_32x32x16_bf16 v[96:111], v[36:39], v[16:19], 0
  buffer_load_dwordx4 v4, s[36:39], s49 offen lds
  v_mfma_f32_32x32x16_bf16 v[112:127], v[36:39], v[20:23], 0
  buffer_load_dwordx4 v[36:39], v10, s[32:35], s50 offen sc1
  s_add_u32 s51, s51, 1
  s_add_u32 s52, s51, s63
  s_sub_u32 s70, s52, 28
  s_cmp_ge_u32 s52, 28
  s_cselect_b32 s52, s70, s52
  s_mul_i32 s49, s52, 262144
  s_lshl_b32 s52, s52, 13
  s_add_u32 s50, s62, s52
  s_branch GM_g2
GL_g2:
  s_waitcnt vmcnt(8)
  ds_read_b64_tr_b16 v[24:25], v6 offset:2048
  ds_read_b64_tr_b16 v[26:27], v6 offset:3072
  ds_read_b64_tr_b16 v[28:29], v7 offset:2048
  ds_read_b64_tr_b16 v[30:31], v7 offset:3072
  s_waitcnt lgkmcnt(4)
  s_add_u32 m0, s48, 0
  v_mfma_f32_32x32x16_bf16 v[64:79], v[32:35], v[16:19], v[64:79]
  buffer_load_dwordx4 v3, s[36:39], s49 offen lds
  s_add_u32 m0, s48, 1024
  v_mfma_f32_32x32x16_bf16 v[80:95], v[32:35], v[20:23], v[80:95]
  buffer_load_dwordx4 v[32:35], v5, s[32:35], s50 offen sc1
  v_mfma_f32_32x32x16_bf16 v[96:111], v[36:39], v[16:19], v[96:111]
  buffer_load_dwordx4 v4, s[36:39], s49 offen lds
  v_mfma_f32_32x32x16_bf16 v[112:127], v[36:39], v[20:23], v[112:127]
  buffer_load_dwordx4 v[36:39], v10, s[32:35], s50 offen sc1
  s_add_u32 s51, s51, 1
  s_add_u32 s52, s51, s63
  s_sub_u32 s70, s52, 28
  s_cmp_ge_u32 s52, 28
  s_cselect_b32 s52, s70, s52
  s_mul_i32 s49, s52, 262144
  s_lshl_b32 s52, s52, 13
  s_add_u32 s50, s62, s52
GM_g2:
  s_waitcnt vmcnt(8)
  ds_read_b64_tr_b16 v[16:17], v6 offset:4096
  ds_read_b64_tr_b16 v[18:19], v6 offset:5120
  ds_read_b64_tr_b16 v[20:21], v7 offset:4096
  ds_read_b64_tr_b16 v[22:23], v7 offset:5120
  s_waitcnt lgkmcnt(4)
  s_add_u32 m0, s48, 2048
  v_mfma_f32_32x32x16_bf16 v[64:79], v[40:43], v[24:27], v[64:79]
  buffer_load_dwordx4 v3, s[36:39], s49 offen lds
  s_add_u32 m0, s48, 3072
  v_mfma_f32_32x32x16_bf16 v[80:95], v[40:43], v[28:31], v[80:95]
  buffer_load_dwordx4 v[40:43], v5, s[32:35], s50 offen sc1
  v_mfma_f32_32x32x16_bf16 v[96:111], v[44:47], v[24:27], v[96:111]
  buffer_load_dwordx4 v4, s[36:39], s49 offen lds
  v_mfma_f32_32x32x16_bf16 v[112:127], v[44:47], v[28:31], v[112:127]
  buffer_load_dwordx4 v[44:47], v10, s[32:35], s50 offen sc1
  s_add_u32 s51, s51, 1
  s_add_u32 s52, s51, s63
  s_sub_u32 s70, s52, 28
  s_cmp_ge_u32 s52, 28
  s_cselect_b32 s52, s70, s52
  s_mul_i32 s49, s52, 262144
  s_lshl_b32 s52, s52, 13
  s_add_u32 s50, s62, s52
  s_waitcnt vmcnt(8)
  ds_read_b64_tr_b16 v[24:25], v6 offset:6144
  ds_read_b64_tr_b16 v[26:27], v6 offset:7168
  ds_read_b64_tr_b16 v[28:29], v7 offset:6144
  ds_read_b64_tr_b16 v[30:31], v7 offset:7168
  s_waitcnt lgkmcnt(4)
  s_add_u32 m0, s48, 4096
  v_mfma_f32_32x32x16_bf16 v[64:79], v[48:51], v[16:19], v[64:79]
  buffer_load_dwordx4 v3, s[36:39], s49 offen lds
  s_add_u32 m0, s48, 5120
  v_mfma_f32_32x32x16_bf16 v[80:95], v[48:51], v[20:23], v[80:95]
  buffer_load_dwordx4 v[48:51], v5, s[32:35], s50 offen sc1
  v_mfma_f32_32x32x16_bf16 v[96:111], v[52:55], v[16:19], v[96:111]
  buffer_load_dwordx4 v4, s[36:39], s49 offen lds
  v_mfma_f32_32x32x16_bf16 v[112:127], v[52:55], v[20:23], v[112:127]
  buffer_load_dwordx4 v[52:55], v10, s[32:35], s50 offen sc1
  s_add_u32 s51, s51, 1
  s_add_u32 s52, s51, s63
  s_sub_u32 s70, s52, 28
  s_cmp_ge_u32 s52, 28
  s_cselect_b32 s52, s70, s52
  s_mul_i32 s49, s52, 262144
  s_lshl_b32 s52, s52, 13
  s_add_u32 s50, s62, s52
  s_waitcnt vmcnt(8)
  ds_read_b64_tr_b16 v[16:17], v6 offset:0
  ds_read_b64_tr_b16 v[18:19], v6 offset:1024
  ds_read_b64_tr_b16 v[20:21], v7 offset:0
  ds_read_b64_tr_b16 v[22:23], v7 offset:1024
  s_waitcnt lgkmcnt(4)
  s_add_u32 m0, s48, 6144
  v_mfma_f32_32x32x16_bf16 v[64:79], v[56:59], v[24:27], v[64:79]
  buffer_load_dwordx4 v3, s[36:39], s49 offen lds
  s_add_u32 m0, s48, 7168
  v_mfma_f32_32x32x16_bf16 v[80:95], v[56:59], v[28:31], v[80:95]
  buffer_load_dwordx4 v[56:59], v5, s[32:35], s50 offen sc1
  v_mfma_f32_32x32x16_bf16 v[96:111], v[60:63], v[24:27], v[96:111]
  buffer_load_dwordx4 v4, s[36:39], s49 offen lds
  v_mfma_f32_32x32x16_bf16 v[112:127], v[60:63], v[28:31], v[112:127]
  buffer_load_dwordx4 v[60:63], v10, s[32:35], s50 offen sc1
  s_add_u32 s51, s51, 1
  s_add_u32 s52, s51, s63
  s_sub_u32 s70, s52, 28
  s_cmp_ge_u32 s52, 28
  s_cselect_b32 s52, s70, s52
  s_mul_i32 s49, s52, 262144
  s_lshl_b32 s52, s52, 13
  s_add_u32 s50, s62, s52
  s_cmp_lt_u32 s51, 28
  s_cbranch_scc1 GL_g2
  v_lshlrev_b32 v12, 7, v1
  s_mov_b64 exec, 0xffff
  buffer_load_dwordx2 v[8:9], v12, s[32:35], s56 offen sc1
  s_mov_b64 exec, -1
  s_waitcnt vmcnt(8)
  ds_read_b64_tr_b16 v[24:25], v6 offset:2048
  ds_read_b64_tr_b16 v[26:27], v6 offset:3072
  ds_read_b64_tr_b16 v[28:29], v7 offset:2048
  ds_read_b64_tr_b16 v[30:31], v7 offset:3072
  s_waitcnt lgkmcnt(4)
  v_mfma_f32_32x32x16_bf16 v[64:79], v[32:35], v[16:19], v[64:79]
  s_add_u32 m0, s55, 0
  s_nop 0
  buffer_load_dwordx4 v13, s[40:43], s64 offen lds
  v_mfma_f32_32x32x16_bf16 v[80:95], v[32:35], v[20:23], v[80:95]
  s_add_u32 m0, s55, 1024
  s_nop 0
  buffer_load_dwordx4 v14, s[40:43], s64 offen lds
  s_add_u32 s64, s64, 16384
  v_mfma_f32_32x32x16_bf16 v[96:111], v[36:39], v[16:19], v[96:111]
  s_add_u32 m0, s55, 2048
  s_nop 0
  buffer_load_dwordx4 v13, s[40:43], s64 offen lds
  v_mfma_f32_32x32x16_bf16 v[112:127], v[36:39], v[20:23], v[112:127]
  s_waitcnt vmcnt(7)
  ds_read_b64_tr_b16 v[16:17], v6 offset:4096
  ds_read_b64_tr_b16 v[18:19], v6 offset:5120
  ds_read_b64_tr_b16 v[20:21], v7 offset:4096
  ds_read_b64_tr_b16 v[22:23], v7 offset:5120
  s_waitcnt lgkmcnt(4)
  v_mfma_f32_32x32x16_bf16 v[64:79], v[40:43], v[24:27], v[64:79]
  s_add_u32 m0, s55, 3072
  s_nop 0
  buffer_load_dwordx4 v14, s[40:43], s64 offen lds
  s_add_u32 s64, s64, 16384
  v_mfma_f32_32x32x16_bf16 v[80:95], v[40:43], v[28:31], v[80:95]
  s_add_u32 m0, s55, 4096
  s_nop 0
  buffer_load_dwordx4 v13, s[40:43], s64 offen lds
  v_mfma_f32_32x32x16_bf16 v[96:111], v[44:47], v[24:27], v[96:111]
  s_add_u32 m0, s55, 5120
  s_nop 0
  buffer_load_dwordx4 v14, s[40:43], s64 offen lds
  s_add_u32 s64, s64, 16384
  v_mfma_f32_32x32x16_bf16 v[112:127], v[44:47], v[28:31], v[112:127]
  s_waitcnt vmcnt(6)
  ds_read_b64_tr_b16 v[24:25], v6 offset:6144
  ds_read_b64_tr_b16 v[26:27], v6 offset:7168
  ds_read_b64_tr_b16 v[28:29], v7 offset:6144
  ds_read_b64_tr_b16 v[30:31], v7 offset:7168
  s_waitcnt lgkmcnt(4)
  v_mfma_f32_32x32x16_bf16 v[64:79], v[48:51], v[16:19], v[64:79]
  s_add_u32 m0, s55, 6144
  s_nop 0
  buffer_load_dwordx4 v13, s[40:43], s64 offen lds
  v_mfma_f32_32x32x16_bf16 v[80:95], v[48:51], v[20:23], v[80:95]
  s_add_u32 m0, s55, 7168
  s_nop 0
  buffer_load_dwordx4 v14, s[40:43], s64 offen lds
  s_add_u32 s64, s64, 16384
  v_mfma_f32_32x32x16_bf16 v[96:111], v[52:55], v[16:19], v[96:111]
  s_add_u32 m0, s55, 8192
  s_nop 0
  buffer_load_dwordx4 v13, s[40:43], s64 offen lds
  v_mfma_f32_32x32x16_bf16 v[112:127], v[52:55], v[20:23], v[112:127]
  s_waitcnt lgkmcnt(0)
  v_mfma_f32_32x32x16_bf16 v[64:79], v[56:59], v[24:27], v[64:79]
  s_add_u32 m0, s55, 9216
  s_nop 0
  buffer_load_dwordx4 v14, s[40:43], s64 offen lds
  s_add_u32 s64, s64, 16384
  v_mfma_f32_32x32x16_bf16 v[80:95], v[56:59], v[28:31], v[80:95]
  s_add_u32 m0, s55, 10240
  s_nop 0
  buffer_load_dwordx4 v13, s[40:43], s64 offen lds
  v_mfma_f32_32x32x16_bf16 v[96:111], v[60:63], v[24:27], v[96:111]
  s_add_u32 m0, s55, 11264
  s_nop 0
  buffer_load_dwordx4 v14, s[40:43], s64 offen lds
  s_add_u32 s64, s64, 16384
  v_mfma_f32_32x32x16_bf16 v[112:127], v[60:63], v[28:31], v[112:127]
  s_setprio 3
  s_lshl_b32 s50, s67, 16
  s_lshl_b32 s59, s65, 15
  s_add_u32 s50, s50, s59
  s_lshl_b32 s60, s66, 10
  s_add_u32 s50, s50, s60
  s_add_u32 s50, s50, 10485760
  s_mov_b64 exec, 0xffff
  v_cmp_ne_u64 vcc, s[28:29], v[8:9]
  s_mov_b64 exec, -1
  s_mov_b32 s69, 0
  s_cbranch_vccnz B_O_LATE0
  s_mov_b32 s69, 1
  buffer_load_dwordx4 v[32:35], v2, s[32:35], s50 offen offset:0 sc1
  buffer_load_dwordx4 v[36:39], v2, s[32:35], s50 offen offset:2048 sc1
  s_add_u32 s50, s50, 4096
  buffer_load_dwordx4 v[40:43], v2, s[32:35], s50 offen offset:0 sc1
  buffer_load_dwordx4 v[44:47], v2, s[32:35], s50 offen offset:2048 sc1
  s_add_u32 s50, s50, 4096
  buffer_load_dwordx4 v[48:51], v2, s[32:35], s50 offen offset:0 sc1
  buffer_load_dwordx4 v[52:55], v2, s[32:35], s50 offen offset:2048 sc1
  s_add_u32 s50, s50, 4096
  buffer_load_dwordx4 v[56:59], v2, s[32:35], s50 offen offset:0 sc1
  buffer_load_dwordx4 v[60:63], v2, s[32:35], s50 offen offset:2048 sc1
  s_add_u32 s50, s50, 4096
B_O_LATE0:
  v_add_u32 v3, s48, v2
  v_xor_b32 v4, 16384, v3
  v_xor_b32 v5, 8192, v3
  ds_write_b128 v3, v[96:99] offset:0
  ds_write_b128 v3, v[100:103] offset:1024
  ds_write_b128 v3, v[104:107] offset:2048
  ds_write_b128 v3, v[108:111] offset:3072
  ds_write_b128 v3, v[112:115] offset:4096
  ds_write_b128 v3, v[116:119] offset:5120
  ds_write_b128 v3, v[120:123] offset:6144
  ds_write_b128 v3, v[124:127] offset:7168
  s_waitcnt lgkmcnt(0)
  s_barrier
  ds_read_b128 v[112:115], v4 offset:4096
  ds_read_b128 v[116:119], v4 offset:5120
  ds_read_b128 v[120:123], v4 offset:6144
  ds_read_b128 v[124:127], v4 offset:7168
  ds_read_b128 v[96:99], v4 offset:0
  ds_read_b128 v[100:103], v4 offset:1024
  ds_read_b128 v[104:107], v4 offset:2048
  ds_read_b128 v[108:111], v4 offset:3072
  s_waitcnt lgkmcnt(4)
  v_pk_add_f32 v[80:81], v[80:81], v[112:113]
  v_pk_add_f32 v[82:83], v[82:83], v[114:115]
  v_pk_add_f32 v[84:85], v[84:85], v[116:117]
  v_pk_add_f32 v[86:87], v[86:87], v[118:119]
  v_pk_add_f32 v[88:89], v[88:89], v[120:121]
  v_pk_add_f32 v[90:91], v[90:91], v[122:123]
  v_pk_add_f32 v[92:93], v[92:93], v[124:125]
  v_pk_add_f32 v[94:95], v[94:95], v[126:127]
  s_waitcnt lgkmcnt(0)
  s_barrier
  ds_write_b128 v3, v[80:83] offset:0
  ds_write_b128 v3, v[84:87] offset:1024
  ds_write_b128 v3, v[88:91] offset:2048
  ds_write_b128 v3, v[92:95] offset:3072
  s_lshl_b32 s64, s65, 3
  s_add_u32 s64, s64, s66
  s_lshl_b32 s64, s64, 1
  s_add_u32 s64, s64, 12
  s_lshl_b32 s64, s64, 14
  s_add_u32 m0, s48, 4096
  s_nop 0
  buffer_load_dwordx4 v13, s[40:43], s64 offen lds
  s_add_u32 m0, s48, 5120
  s_nop 0
  buffer_load_dwordx4 v14, s[40:43], s64 offen lds
  s_add_u32 s64, s64, 16384
  s_add_u32 m0, s48, 6144
  s_nop 0
  buffer_load_dwordx4 v13, s[40:43], s64 offen lds
  s_add_u32 m0, s48, 7168
  s_nop 0
  buffer_load_dwordx4 v14, s[40:43], s64 offen lds
  s_add_u32 s64, s64, 16384
  v_pk_add_f32 v[64:65], v[64:65], v[96:97]
  v_pk_add_f32 v[66:67], v[66:67], v[98:99]
  v_pk_add_f32 v[68:69], v[68:69], v[100:101]
  v_pk_add_f32 v[70:71], v[70:71], v[102:103]
  v_pk_add_f32 v[72:73], v[72:73], v[104:105]
  v_pk_add_f32 v[74:75], v[74:75], v[106:107]
  v_pk_add_f32 v[76:77], v[76:77], v[108:109]
  v_pk_add_f32 v[78:79], v[78:79], v[110:111]
  s_waitcnt lgkmcnt(0)
  s_barrier
  ds_read_b128 v[80:83], v5 offset:0
  ds_read_b128 v[84:87], v5 offset:1024
  ds_read_b128 v[88:91], v5 offset:2048
  ds_read_b128 v[92:95], v5 offset:3072
  s_cmp_eq_u32 s69, 0
  s_cbranch_scc1 B_O_LATE1
  buffer_load_dwordx4 v[112:115], v2, s[32:35], s50 offen offset:0 sc1
  buffer_load_dwordx4 v[116:119], v2, s[32:35], s50 offen offset:2048 sc1
  s_add_u32 s50, s50, 4096
  buffer_load_dwordx4 v[120:123], v2, s[32:35], s50 offen offset:0 sc1
  buffer_load_dwordx4 v[124:127], v2, s[32:35], s50 offen offset:2048 sc1
  s_add_u32 s50, s50, 4096
B_O_LATE1:
  s_mul_i32 s59, s65, 24576
  s_add_u32 s59, s59, 32768
  v_lshrrev_b32 v8, 5, v1
  v_lshlrev_b32 v6, 9, v8
  v_bfe_u32 v8, v1, 2, 2
  v_lshl_add_u32 v6, v8, 7, v6
  v_lshrrev_b32 v8, 1, v8
  v_xor_b32 v8, s65, v8
  v_lshl_add_u32 v6, v8, 6, v6
  v_bfe_u32 v8, v1, 4, 1
  v_lshl_add_u32 v6, v8, 5, v6
  v_and_b32 v8, 3, v1
  v_lshl_add_u32 v6, v8, 3, v6
  v_add_u32 v6, s59, v6
  v_xor_b32 v7, 64, v6
  s_lshl_b32 s60, s65, 14
  s_add_u32 s60, s60, 4096
  s_sub_u32 s60, s60, s59
  v_add_u32 v13, s60, v6
  v_add_u32 v14, s60, v7
  v_sub_f32 v9, 1.0, v11
  s_waitcnt lgkmcnt(0)
  v_pk_add_f32 v[64:65], v[64:65], v[80:81]
  v_pk_add_f32 v[66:67], v[66:67], v[82:83]
  v_pk_add_f32 v[68:69], v[68:69], v[84:85]
  v_pk_add_f32 v[70:71], v[70:71], v[86:87]
  v_pk_add_f32 v[72:73], v[72:73], v[88:89]
  v_pk_add_f32 v[74:75], v[74:75], v[90:91]
  v_pk_add_f32 v[76:77], v[76:77], v[92:93]
  v_pk_add_f32 v[78:79], v[78:79], v[94:95]
  v_mul_f32 v64, v64, v9
  v_mul_f32 v65, v65, v9
  v_mul_f32 v66, v66, v9
  v_mul_f32 v67, v67, v9
  v_mul_f32 v68, v68, v9
  v_mul_f32 v69, v69, v9
  v_mul_f32 v70, v70, v9
  v_mul_f32 v71, v71, v9
  v_mul_f32 v72, v72, v9
  v_mul_f32 v73, v73, v9
  v_mul_f32 v74, v74, v9
  v_mul_f32 v75, v75, v9
  v_mul_f32 v76, v76, v9
  v_mul_f32 v77, v77, v9
  v_mul_f32 v78, v78, v9
  v_mul_f32 v79, v79, v9
  v_and_b32 v10, 31, v1
  v_lshlrev_b32 v10, 10, v10
  v_lshrrev_b32 v9, 5, v1
  v_lshl_add_u32 v10, v9, 4, v10
  s_lshl_b32 s55, s67, 16
  s_lshl_b32 s60, s66, 15
  s_add_u32 s55, s55, s60
  s_add_u32 s55, s55, s57
  s_lshl_b32 s60, s65, 6
  s_add_u32 s55, s55, s60
  s_cmp_eq_u32 s69, 0
  s_cbranch_scc1 B_O_LATE2
  s_waitcnt vmcnt(4)
  s_barrier
  s_branch B_O_GO
B_O_LATE2:
  s_waitcnt vmcnt(0)
  s_barrier
  s_mov_b32 s71, 20000
  s_mov_b32 exec_lo, 0xffff
  s_mov_b32 exec_hi, 0
PL_o:
  buffer_load_dwordx2 v[16:17], v12, s[32:35], s56 offen sc1
  s_waitcnt vmcnt(0)
  v_cmp_ne_u64 vcc, s[28:29], v[16:17]
  s_cbranch_vccz PD_o
  s_mov_b64 exec, vcc
  s_sleep 2
  s_sub_u32 s71, s71, 1
  s_cmp_lg_u32 s71, 0
  s_cbranch_scc1 PL_o
PD_o:
  s_mov_b64 exec, -1
  buffer_load_dwordx4 v[32:35], v2, s[32:35], s50 offen offset:0 sc1
  buffer_load_dwordx4 v[36:39], v2, s[32:35], s50 offen offset:2048 sc1
  s_add_u32 s50, s50, 4096
  buffer_load_dwordx4 v[40:43], v2, s[32:35], s50 offen offset:0 sc1
  buffer_load_dwordx4 v[44:47], v2, s[32:35], s50 offen offset:2048 sc1
  s_add_u32 s50, s50, 4096
  buffer_load_dwordx4 v[48:51], v2, s[32:35], s50 offen offset:0 sc1
  buffer_load_dwordx4 v[52:55], v2, s[32:35], s50 offen offset:2048 sc1
  s_add_u32 s50, s50, 4096
  buffer_load_dwordx4 v[56:59], v2, s[32:35], s50 offen offset:0 sc1
  buffer_load_dwordx4 v[60:63], v2, s[32:35], s50 offen offset:2048 sc1
  s_add_u32 s50, s50, 4096
  buffer_load_dwordx4 v[112:115], v2, s[32:35], s50 offen offset:0 sc1
  buffer_load_dwordx4 v[116:119], v2, s[32:35], s50 offen offset:2048 sc1
  s_add_u32 s50, s50, 4096
  buffer_load_dwordx4 v[120:123], v2, s[32:35], s50 offen offset:0 sc1
  buffer_load_dwordx4 v[124:127], v2, s[32:35], s50 offen offset:2048 sc1
  s_add_u32 s50, s50, 4096
B_O_GO:
  ds_read_b64_tr_b16 v[16:17], v6 offset:0
  ds_read_b64_tr_b16 v[18:19], v6 offset:1024
  ds_read_b64_tr_b16 v[20:21], v7 offset:0
  ds_read_b64_tr_b16 v[22:23], v7 offset:1024
  ds_read_b64_tr_b16 v[24:25], v6 offset:2048
  ds_read_b64_tr_b16 v[26:27], v6 offset:3072
  ds_read_b64_tr_b16 v[28:29], v7 offset:2048
  ds_read_b64_tr_b16 v[30:31], v7 offset:3072
  s_waitcnt vmcnt(11) lgkmcnt(4)
  v_mfma_f32_32x32x16_bf16 v[96:111], v[20:23], v[32:35], 0
  v_mfma_f32_32x32x16_bf16 v[80:95], v[16:19], v[32:35], 0
  buffer_load_dwordx4 v[32:35], v2, s[32:35], s50 offen offset:0 sc1
  ds_read_b64_tr_b16 v[16:17], v6 offset:4096
  ds_read_b64_tr_b16 v[18:19], v6 offset:5120
  ds_read_b64_tr_b16 v[20:21], v7 offset:4096
  ds_read_b64_tr_b16 v[22:23], v7 offset:5120
  s_waitcnt vmcnt(11) lgkmcnt(4)
  v_mfma_f32_32x32x16_bf16 v[96:111], v[28:31], v[36:39], v[96:111]
  v_mfma_f32_32x32x16_bf16 v[80:95], v[24:27], v[36:39], v[80:95]
  buffer_load_dwordx4 v[36:39], v2, s[32:35], s50 offen offset:2048 sc1
  s_add_u32 s50, s50, 4096
  ds_read_b64_tr_b16 v[24:25], v6 offset:6144
  ds_read_b64_tr_b16 v[26:27], v6 offset:7168
  ds_read_b64_tr_b16 v[28:29], v7 offset:6144
  ds_read_b64_tr_b16 v[30:31], v7 offset:7168
  s_waitcnt vmcnt(11) lgkmcnt(4)
  v_mfma_f32_32x32x16_bf16 v[96:111], v[20:23], v[40:43], v[96:111]
  v_mfma_f32_32x32x16_bf16 v[80:95], v[16:19], v[40:43], v[80:95]
  buffer_load_dwordx4 v[40:43], v2, s[32:35], s50 offen offset:0 sc1
  ds_read_b64_tr_b16 v[16:17], v6 offset:8192
  ds_read_b64_tr_b16 v[18:19], v6 offset:9216
  ds_read_b64_tr_b16 v[20:21], v7 offset:8192
  ds_read_b64_tr_b16 v[22:23], v7 offset:9216
  s_waitcnt vmcnt(11) lgkmcnt(4)
  v_mfma_f32_32x32x16_bf16 v[96:111], v[28:31], v[44:47], v[96:111]
  v_mfma_f32_32x32x16_bf16 v[80:95], v[24:27], v[44:47], v[80:95]
  buffer_load_dwordx4 v[44:47], v2, s[32:35], s50 offen offset:2048 sc1
  s_add_u32 s50, s50, 4096
  ds_read_b64_tr_b16 v[24:25], v6 offset:10240
  ds_read_b64_tr_b16 v[26:27], v6 offset:11264
  ds_read_b64_tr_b16 v[28:29], v7 offset:10240
  ds_read_b64_tr_b16 v[30:31], v7 offset:11264
  s_waitcnt vmcnt(11) lgkmcnt(4)
  v_mfma_f32_32x32x16_bf16 v[96:111], v[20:23], v[48:51], v[96:111]
  v_mfma_f32_32x32x16_bf16 v[80:95], v[16:19], v[48:51], v[80:95]
  ds_read_b64_tr_b16 v[16:17], v6 offset:12288
  ds_read_b64_tr_b16 v[18:19], v6 offset:13312
  ds_read_b64_tr_b16 v[20:21], v7 offset:12288
  ds_read_b64_tr_b16 v[22:23], v7 offset:13312
  s_waitcnt vmcnt(10) lgkmcnt(4)
  v_mfma_f32_32x32x16_bf16 v[96:111], v[28:31], v[52:55], v[96:111]
  v_mfma_f32_32x32x16_bf16 v[80:95], v[24:27], v[52:55], v[80:95]
  ds_read_b64_tr_b16 v[24:25], v6 offset:14336
  ds_read_b64_tr_b16 v[26:27], v6 offset:15360
  ds_read_b64_tr_b16 v[28:29], v7 offset:14336
  ds_read_b64_tr_b16 v[30:31], v7 offset:15360
  s_waitcnt vmcnt(9) lgkmcnt(4)
  v_mfma_f32_32x32x16_bf16 v[96:111], v[20:23], v[56:59], v[96:111]
  v_mfma_f32_32x32x16_bf16 v[80:95], v[16:19], v[56:59], v[80:95]
  ds_read_b64_tr_b16 v[16:17], v6 offset:16384
  ds_read_b64_tr_b16 v[18:19], v6 offset:17408
  ds_read_b64_tr_b16 v[20:21], v7 offset:16384
  ds_read_b64_tr_b16 v[22:23], v7 offset:17408
  s_waitcnt vmcnt(8) lgkmcnt(4)
  v_mfma_f32_32x32x16_bf16 v[96:111], v[28:31], v[60:63], v[96:111]
  v_mfma_f32_32x32x16_bf16 v[80:95], v[24:27], v[60:63], v[80:95]
  ds_read_b64_tr_b16 v[24:25], v6 offset:18432
  ds_read_b64_tr_b16 v[26:27], v6 offset:19456
  ds_read_b64_tr_b16 v[28:29], v7 offset:18432
  ds_read_b64_tr_b16 v[30:31], v7 offset:19456
  s_waitcnt vmcnt(7) lgkmcnt(4)
  v_mfma_f32_32x32x16_bf16 v[96:111], v[20:23], v[112:115], v[96:111]
  v_mfma_f32_32x32x16_bf16 v[80:95], v[16:19], v[112:115], v[80:95]
  ds_read_b64_tr_b16 v[16:17], v6 offset:20480
  ds_read_b64_tr_b16 v[18:19], v6 offset:21504
  ds_read_b64_tr_b16 v[20:21], v7 offset:20480
  ds_read_b64_tr_b16 v[22:23], v7 offset:21504
  s_waitcnt vmcnt(6) lgkmcnt(4)
  v_mfma_f32_32x32x16_bf16 v[96:111], v[28:31], v[116:119], v[96:111]
  v_mfma_f32_32x32x16_bf16 v[80:95], v[24:27], v[116:119], v[80:95]
  ds_read_b64_tr_b16 v[24:25], v6 offset:22528
  ds_read_b64_tr_b16 v[26:27], v6 offset:23552
  ds_read_b64_tr_b16 v[28:29], v7 offset:22528
  ds_read_b64_tr_b16 v[30:31], v7 offset:23552
  s_waitcnt vmcnt(5) lgkmcnt(4)
  v_mfma_f32_32x32x16_bf16 v[96:111], v[20:23], v[120:123], v[96:111]
  v_mfma_f32_32x32x16_bf16 v[80:95], v[16:19], v[120:123], v[80:95]
  ds_read_b64_tr_b16 v[16:17], v13 offset:0
  ds_read_b64_tr_b16 v[18:19], v13 offset:1024
  ds_read_b64_tr_b16 v[20:21], v14 offset:0
  ds_read_b64_tr_b16 v[22:23], v14 offset:1024
  s_waitcnt vmcnt(4) lgkmcnt(4)
  v_mfma_f32_32x32x16_bf16 v[96:111], v[28:31], v[124:127], v[96:111]
  v_mfma_f32_32x32x16_bf16 v[80:95], v[24:27], v[124:127], v[80:95]
  ds_read_b64_tr_b16 v[24:25], v13 offset:2048
  ds_read_b64_tr_b16 v[26:27], v13 offset:3072
  ds_read_b64_tr_b16 v[28:29], v14 offset:2048
  ds_read_b64_tr_b16 v[30:31], v14 offset:3072
  s_waitcnt vmcnt(3) lgkmcnt(4)
  v_mfma_f32_32x32x16_bf16 v[96:111], v[20:23], v[32:35], v[96:111]
  v_mfma_f32_32x32x16_bf16 v[80:95], v[16:19], v[32:35], v[80:95]
  ds_read_b64_tr_b16 v[16:17], v13 offset:8192
  ds_read_b64_tr_b16 v[18:19], v13 offset:9216
  ds_read_b64_tr_b16 v[20:21], v14 offset:8192
  ds_read_b64_tr_b16 v[22:23], v14 offset:9216
  s_waitcnt vmcnt(2) lgkmcnt(4)
  v_mfma_f32_32x32x16_bf16 v[96:111], v[28:31], v[36:39], v[96:111]
  v_mfma_f32_32x32x16_bf16 v[80:95], v[24:27], v[36:39], v[80:95]
  ds_read_b64_tr_b16 v[24:25], v13 offset:10240
  ds_read_b64_tr_b16 v[26:27], v13 offset:11264
  ds_read_b64_tr_b16 v[28:29], v14 offset:10240
  ds_read_b64_tr_b16 v[30:31], v14 offset:11264
  s_waitcnt vmcnt(1) lgkmcnt(4)
  v_mfma_f32_32x32x16_bf16 v[96:111], v[20:23], v[40:43], v[96:111]
  v_mfma_f32_32x32x16_bf16 v[80:95], v[16:19], v[40:43], v[80:95]
  s_waitcnt vmcnt(0) lgkmcnt(0)
  v_mfma_f32_32x32x16_bf16 v[96:111], v[28:31], v[44:47], v[96:111]
  v_mfma_f32_32x32x16_bf16 v[80:95], v[24:27], v[44:47], v[80:95]
  s_nop 10
  ds_write_b128 v3, v[96:99] offset:0
  ds_write_b128 v3, v[100:103] offset:1024
  ds_write_b128 v3, v[104:107] offset:2048
  ds_write_b128 v3, v[108:111] offset:3072
  s_waitcnt lgkmcnt(0)
  s_barrier
  ds_read_b128 v[96:99], v4 offset:0
  ds_read_b128 v[100:103], v4 offset:1024
  ds_read_b128 v[104:107], v4 offset:2048
  ds_read_b128 v[108:111], v4 offset:3072
  v_fma_f32 v64, v80, v11, v64
  v_fma_f32 v65, v81, v11, v65
  v_fma_f32 v66, v82, v11, v66
  v_fma_f32 v67, v83, v11, v67
  v_fma_f32 v68, v84, v11, v68
  v_fma_f32 v69, v85, v11, v69
  v_fma_f32 v70, v86, v11, v70
  v_fma_f32 v71, v87, v11, v71
  v_fma_f32 v72, v88, v11, v72
  v_fma_f32 v73, v89, v11, v73
  v_fma_f32 v74, v90, v11, v74
  v_fma_f32 v75, v91, v11, v75
  v_fma_f32 v76, v92, v11, v76
  v_fma_f32 v77, v93, v11, v77
  v_fma_f32 v78, v94, v11, v78
  v_fma_f32 v79, v95, v11, v79
  s_waitcnt lgkmcnt(0)
  v_fma_f32 v64, v96, v11, v64
  v_fma_f32 v65, v97, v11, v65
  v_fma_f32 v66, v98, v11, v66
  v_fma_f32 v67, v99, v11, v67
  v_fma_f32 v68, v100, v11, v68
  v_fma_f32 v69, v101, v11, v69
  v_fma_f32 v70, v102, v11, v70
  v_fma_f32 v71, v103, v11, v71
  v_fma_f32 v72, v104, v11, v72
  v_fma_f32 v73, v105, v11, v73
  v_fma_f32 v74, v106, v11, v74
  v_fma_f32 v75, v107, v11, v75
  v_fma_f32 v76, v108, v11, v76
  v_fma_f32 v77, v109, v11, v77
  v_fma_f32 v78, v110, v11, v78
  v_fma_f32 v79, v111, v11, v79
  v_cvt_pk_bf16_f32 v80, v64, v65
  v_cvt_pk_bf16_f32 v81, v66, v67
  v_cvt_pk_bf16_f32 v82, v68, v69
  v_cvt_pk_bf16_f32 v83, v70, v71
  v_cvt_pk_bf16_f32 v84, v72, v73
  v_cvt_pk_bf16_f32 v85, v74, v75
  v_cvt_pk_bf16_f32 v86, v76, v77
  v_cvt_pk_bf16_f32 v87, v78, v79
  v_permlane32_swap_b32 v80, v82
  v_permlane32_swap_b32 v81, v83
  v_permlane32_swap_b32 v84, v86
  v_permlane32_swap_b32 v85, v87
  buffer_store_dwordx4 v[80:83], v10, s[44:47], s55 offen
  buffer_store_dwordx4 v[84:87], v10, s[44:47], s55 offen offset:32
  s_cmp_lg_u32 s2, 0
  s_cbranch_scc1 B_END
  s_mov_b32 s59, 12615680
  s_cmp_lg_u32 s30, 0
  s_cbranch_scc1 PF_e
  v_mov_b32 v16, s28
  v_mov_b32 v17, s29
  v_mov_b32 v18, 0
  s_mov_b64 exec, 1
  buffer_store_dwordx2 v[16:17], v18, s[32:35], s59 offen sc1
  s_mov_b64 exec, -1
PF_e:
B_END:
  s_endpgm
K_END:
  s_endpgm
.section .rodata,"a"
.p2align 6
.amdhsa_kernel gated_mix__mha_block__mixer_token_mlp__prompt_kernel
  .amdhsa_next_free_vgpr 128
  .amdhsa_next_free_sgpr 96
  .amdhsa_accum_offset 128
  .amdhsa_group_segment_fixed_size 0
  .amdhsa_kernarg_size 96
  .amdhsa_user_sgpr_count 2
  .amdhsa_user_sgpr_kernarg_segment_ptr 1
  .amdhsa_system_sgpr_workgroup_id_x 1
.end_amdhsa_kernel
```
